```python
import torch

def _softmax(x, axis=-1):
    return torch.softmax(x, dim=axis)
def _gelu(x):
    return torch.nn.functional.gelu(x, approximate="tanh")
def _silu(x):
    return torch.nn.functional.silu(x)
def _sigmoid(x):
    return torch.sigmoid(x)
def _layernorm(x, axis=-1, eps=1e-5):
    m = x.mean(dim=axis, keepdim=True)
    v = x.var(dim=axis, keepdim=True, unbiased=False)
    return (x - m) / torch.sqrt(v + eps)
def _scatter_add(tgt, idx, src, axis=0):
    return tgt.clone().index_add_(axis, idx, src)
def _segment_sum(src, seg, n):
    out = torch.zeros((n,) + src.shape[1:], dtype=src.dtype)
    return out.index_add_(0, seg, src)
def _pad(x, pw):
    flat = tuple(v for pair in reversed(pw) for v in pair)
    return torch.nn.functional.pad(x, flat)

kernel_name = 'gated_mix__sliding_block_cached__mixer_channel_mlp__decode'

def setup_inputs():

    _w = (lambda a: (lambda t: t.to(torch.bfloat16) if t.is_floating_point() else t)(torch.as_tensor(a)))
    def _A_setup():
        B, Sq, D = 4, 1, 512
        Hq, Hkv, Sk, Dh = 32, 8, 4096, 128
        assert Hq % Hkv == 0, (Hq, Hkv)
        return {
            "x": _w((lambda *s: torch.randn(*s, dtype=torch.bfloat16) * 0.05)(B, Sq, D)),
            "k_cache": _w((lambda *s: torch.randn(*s, dtype=torch.bfloat16) * 6.4)(B, Hkv, Sk, Dh)),
            "v_cache": _w((lambda *s: torch.randn(*s, dtype=torch.bfloat16) * 0.4)(B, Hkv, Sk, Dh)),
            "wq": _w((lambda *s: torch.randn(*s, dtype=torch.bfloat16) * 6.4)(D, Hq * Dh) * (D ** -0.5)),
            "wo": _w((lambda *s: torch.randn(*s, dtype=torch.bfloat16) * 0.4)(Hq * Dh, D) * ((Hq * Dh) ** -0.5)),
        }
    _A_in = _A_setup()

    def _B_setup():
        B, S, D, F = 4, 1, 512, 1792
        return {
            "x": _w((lambda *s: torch.randn(*s, dtype=torch.bfloat16) * 0.05)(B, S, D)),
            "w1": _w((lambda *s: torch.randn(*s, dtype=torch.bfloat16) * 0.8)(D, F) * (D ** -0.5)),
            "b1": _w((lambda *s: torch.randn(*s, dtype=torch.bfloat16) * 0.8)(F)),
            "w2": _w((lambda *s: torch.randn(*s, dtype=torch.bfloat16) * 0.05)(F, D) * (F ** -0.5)),
            "b2": _w((lambda *s: torch.randn(*s, dtype=torch.bfloat16) * 0.05)(D)),
        }
    _B_in = _B_setup()

    return {
        "A_x": _A_in["x"],
        "A_k_cache": _A_in["k_cache"],
        "A_v_cache": _A_in["v_cache"],
        "A_wq": _A_in["wq"],
        "A_wo": _A_in["wo"],
        "B_x": _B_in["x"],
        "B_w1": _B_in["w1"],
        "B_b1": _B_in["b1"],
        "B_w2": _B_in["w2"],
        "B_b2": _B_in["b2"],
        "gate_w": _w((lambda *s: torch.randn(*s, dtype=torch.bfloat16) * 0.05)(512) * 16.0),
    }

def reference(A_x, A_k_cache, A_v_cache, A_wq, A_wo, B_x, B_w1, B_b1, B_w2, B_b2, gate_w):
    def _A_ref(x, k_cache, v_cache, wq, wo):
        B, Sq, D = x.shape
        Hq, Dh = 32, 128
        Hkv, Sk = k_cache.shape[1], k_cache.shape[2]
        W = min(4096, max(256, Sk // 4))
        rep = Hq // Hkv
        q = (lambda x, *d: x.permute(*d))((x @ wq).reshape(B, Sq, Hq, Dh), 0, 2, 1, 3)
        k = (lambda x, n, axis: torch.repeat_interleave(x, n, dim=axis))(k_cache[:, :, Sk - W:, :], rep, axis=1)
        v = (lambda x, n, axis: torch.repeat_interleave(x, n, dim=axis))(v_cache[:, :, Sk - W:, :], rep, axis=1)
        scores = torch.einsum("bhqd,bhkd->bhqk", q, k) * (Dh ** -0.5)
        p = _softmax(scores, axis=-1)
        o = torch.einsum("bhqk,bhkd->bhqd", p, v)
        return (lambda x, *d: x.permute(*d))(o, 0, 2, 1, 3).reshape(B, Sq, Hq * Dh) @ wo

    def _B_ref(x, w1, b1, w2, b2):
        y = _layernorm(x, axis=-1)
        h = _gelu(torch.einsum("bsd,df->bsf", y, w1) + b1)
        return torch.einsum("bsf,fd->bsd", h, w2) + b2

    x = A_x
    g = _sigmoid((x * gate_w).sum(-1, keepdims=True))
    a = _A_ref(x, A_k_cache, A_v_cache, A_wq, A_wo)
    b = _B_ref(x, B_w1, B_b1, B_w2, B_b2)
    return g * a + (1 - g) * b
```

```asm
; @launch grid=(256,1,1) block=(512,1,1) lds=20480
.amdgcn_target "amdgcn-amd-amdhsa--gfx950"
.text
.globl gated_mix__sliding_block_cached__mixer_channel_mlp__decode_kernel
.p2align 8
.type gated_mix__sliding_block_cached__mixer_channel_mlp__decode_kernel,@function
gated_mix__sliding_block_cached__mixer_channel_mlp__decode_kernel:
    s_cmp_ge_u32 s2, 256
    s_cbranch_scc1 L_exit
    s_load_dwordx16 s[16:31], s[0:1], 0
    s_load_dwordx8 s[32:39], s[0:1], 64
    s_load_dwordx4 s[40:43], s[0:1], 96
    v_lshrrev_b32 v1, 6, v0
    v_and_b32 v0, 63, v0
    s_mov_b32 s78, 0x05040100
    s_mov_b32 s79, 0x07060302
    s_mov_b32 s96, 0x3ff
    s_mov_b32 s97, 0
    v_readfirstlane_b32 s3, v1
    v_and_b32 v1, 7, v0
    v_bfe_u32 v2, v0, 3, 1
    v_lshrrev_b32 v3, 4, v0
    v_lshlrev_b32 v4, 5, v2
    v_lshl_add_u32 v4, v3, 3, v4
    v_and_b32 v5, 3, v0
    v_bfe_u32 v6, v0, 2, 1
    v_lshlrev_b32 v6, 5, v6
    v_lshl_add_u32 v6, v3, 3, v6
    v_lshlrev_b32 v11, 1, v6
    v_lshl_add_u32 v6, v5, 10, v11
    v_lshl_add_u32 v11, v5, 8, v11
    v_lshlrev_b32 v10, 5, v1
    v_lshl_add_u32 v10, v2, 10, v10
    s_waitcnt lgkmcnt(0)
    s_mov_b32 s44, s16
    s_and_b32 s45, s17, 0xffff
    s_mov_b32 s46, 4096
    s_mov_b32 s47, 0x00020000
    s_mov_b32 s64, s42
    s_and_b32 s65, s43, 0xffff
    s_mov_b32 s66, 2523136
    s_mov_b32 s67, 0x00020000
    s_cmp_ge_u32 s3, 4
    s_cbranch_scc1 L_comm
    s_mov_b32 s48, s18
    s_and_b32 s49, s19, 0xffff
    s_mov_b32 s50, 33554432
    s_mov_b32 s51, 0x00020000
    s_mov_b32 s52, s20
    s_and_b32 s53, s21, 0xffff
    s_mov_b32 s54, 33554432
    s_mov_b32 s55, 0x00020000
    s_lshr_b32 s10, s2, 3
    s_lshl_b32 s10, s10, 12
    s_and_b32 s11, s2, 7
    s_lshl_b32 s11, s11, 7
    s_add_u32 s10, s10, s11
    s_lshl_b32 s11, s3, 5
    s_add_u32 s10, s10, s11
    s_add_u32 s10, s10, 3072
    s_lshl_b32 s10, s10, 8
    s_add_u32 s11, s10, 4096
    v_and_b32 v8, 15, v0
    v_lshlrev_b32 v9, 4, v8
    v_lshlrev_b32 v8, 8, v8
    v_lshl_add_u32 v8, v3, 4, v8
    v_lshl_add_u32 v9, v3, 10, v9
    v_mov_b32 v2, 0
    buffer_load_dwordx2 v[186:187], v2, s[64:67], 0 offen offset:0 sc1
    buffer_load_dwordx4 v[80:83], v8, s[48:51], s10 offen offset:0 nt
    buffer_load_dwordx4 v[84:87], v8, s[48:51], s10 offen offset:64 nt
    buffer_load_dwordx4 v[88:91], v8, s[48:51], s10 offen offset:128 nt
    buffer_load_dwordx4 v[92:95], v8, s[48:51], s10 offen offset:192 nt
    s_barrier
    s_waitcnt vmcnt(3)
    buffer_load_dwordx4 v[96:99], v8, s[48:51], s11 offen offset:0 nt
    s_waitcnt vmcnt(3)
    buffer_load_dwordx4 v[100:103], v8, s[48:51], s11 offen offset:64 nt
    s_waitcnt vmcnt(3)
    buffer_load_dwordx4 v[104:107], v8, s[48:51], s11 offen offset:128 nt
    s_waitcnt vmcnt(3)
    buffer_load_dwordx4 v[108:111], v8, s[48:51], s11 offen offset:192 nt
    s_waitcnt vmcnt(3)
    buffer_load_dwordx4 v[112:115], v9, s[52:55], s10 offen offset:0 nt
    s_waitcnt vmcnt(3)
    buffer_load_dwordx4 v[116:119], v9, s[52:55], s10 offen offset:256 nt
    s_waitcnt vmcnt(3)
    buffer_load_dwordx4 v[120:123], v9, s[52:55], s10 offen offset:512 nt
    s_waitcnt vmcnt(3)
    buffer_load_dwordx4 v[124:127], v9, s[52:55], s10 offen offset:768 nt
    s_waitcnt vmcnt(3)
    buffer_load_dwordx4 v[128:131], v9, s[52:55], s11 offen offset:0 nt
    s_waitcnt vmcnt(3)
    buffer_load_dwordx4 v[132:135], v9, s[52:55], s11 offen offset:256 nt
    s_waitcnt vmcnt(3)
    buffer_load_dwordx4 v[136:139], v9, s[52:55], s11 offen offset:512 nt
    s_waitcnt vmcnt(3)
    buffer_load_dwordx4 v[140:143], v9, s[52:55], s11 offen offset:768 nt
    v_readfirstlane_b32 s76, v186
    v_readfirstlane_b32 s77, v187
    s_nop 3
    s_add_u32 s76, s76, 1
    s_addc_u32 s77, s77, 0
    s_and_b32 s80, s76, 0x3ff
    s_bfe_u32 s81, s76, 0xa000a
    s_bfe_u32 s82, s76, 0xa0014
    s_lshr_b64 s[84:85], s[76:77], 30
    s_and_b32 s83, s84, 0x3ff
    v_mov_b32 v188, s80
    v_mov_b32 v189, s81
    v_mov_b32 v190, s82
    v_mov_b32 v191, s83
L_secA:
    s_waitcnt vmcnt(8)
    v_and_b32 v1, 3, v0
    v_lshlrev_b32 v1, 8, v1
    v_lshl_add_u32 v1, v3, 4, v1
    v_mov_b32 v192, 19840
    s_mov_b32 s91, 4000000
L_lw1:
    ds_read_b32 v193, v192
    s_waitcnt lgkmcnt(0)
    v_readfirstlane_b32 s92, v193
    s_nop 1
    s_nop 1
    s_cmp_ge_u32 s92, 2
    s_cbranch_scc1 L_lwd1
    s_sub_u32 s91, s91, 1
    s_cmp_eq_u32 s91, 0
    s_cbranch_scc1 L_lwd1
    s_sleep 1
    s_branch L_lw1
L_lwd1:
    ds_read_b128 v[192:195], v1 offset:8192
    ds_read_b128 v[196:199], v1 offset:8256
    ds_read_b128 v[200:203], v1 offset:8320
    ds_read_b128 v[204:207], v1 offset:8384
    s_waitcnt lgkmcnt(0)
    v_mfma_f32_16x16x32_bf16 v[152:155], v[80:83], v[192:195], 0
    v_mfma_f32_16x16x32_bf16 v[152:155], v[84:87], v[196:199], v[152:155]
    v_mfma_f32_16x16x32_bf16 v[152:155], v[88:91], v[200:203], v[152:155]
    v_mfma_f32_16x16x32_bf16 v[152:155], v[92:95], v[204:207], v[152:155]
    v_mfma_f32_16x16x32_bf16 v[156:159], v[96:99], v[192:195], 0
    v_mfma_f32_16x16x32_bf16 v[156:159], v[100:103], v[196:199], v[156:159]
    v_mfma_f32_16x16x32_bf16 v[156:159], v[104:107], v[200:203], v[156:159]
    v_mfma_f32_16x16x32_bf16 v[156:159], v[108:111], v[204:207], v[156:159]
    s_nop 7
    s_nop 1
    v_cvt_pk_bf16_f32 v216, v152, v153
    v_lshlrev_b32 v208, 16, v216
    v_and_b32 v209, 0xffff0000, v216
    v_mul_f32 v208, 0x3db504f3, v208
    v_mul_f32 v209, 0x3db504f3, v209
    v_cvt_pk_bf16_f32 v216, v208, v209
    v_lshlrev_b32 v208, 16, v216
    v_and_b32 v209, 0xffff0000, v216
    v_cvt_pk_bf16_f32 v216, v154, v155
    v_lshlrev_b32 v210, 16, v216
    v_and_b32 v211, 0xffff0000, v216
    v_mul_f32 v210, 0x3db504f3, v210
    v_mul_f32 v211, 0x3db504f3, v211
    v_cvt_pk_bf16_f32 v216, v210, v211
    v_lshlrev_b32 v210, 16, v216
    v_and_b32 v211, 0xffff0000, v216
    v_cvt_pk_bf16_f32 v216, v156, v157
    v_lshlrev_b32 v212, 16, v216
    v_and_b32 v213, 0xffff0000, v216
    v_mul_f32 v212, 0x3db504f3, v212
    v_mul_f32 v213, 0x3db504f3, v213
    v_cvt_pk_bf16_f32 v216, v212, v213
    v_lshlrev_b32 v212, 16, v216
    v_and_b32 v213, 0xffff0000, v216
    v_cvt_pk_bf16_f32 v216, v158, v159
    v_lshlrev_b32 v214, 16, v216
    v_and_b32 v215, 0xffff0000, v216
    v_mul_f32 v214, 0x3db504f3, v214
    v_mul_f32 v215, 0x3db504f3, v215
    v_cvt_pk_bf16_f32 v216, v214, v215
    v_lshlrev_b32 v214, 16, v216
    v_and_b32 v215, 0xffff0000, v216
    v_max3_f32 v218, v208, v209, v210
    v_max3_f32 v218, v218, v211, v212
    v_max3_f32 v218, v218, v213, v214
    v_max_f32 v218, v218, v215
    v_mov_b32 v216, v218
    s_nop 1
    v_permlane16_swap_b32 v218, v216
    s_nop 1
    v_max_f32 v218, v218, v216
    v_mov_b32 v216, v218
    s_nop 1
    v_permlane32_swap_b32 v218, v216
    s_nop 1
    v_max_f32 v218, v218, v216
    v_sub_f32 v208, v208, v218
    v_mul_f32 v208, 0x3fb8aa3b, v208
    v_exp_f32 v208, v208
    v_sub_f32 v209, v209, v218
    v_mul_f32 v209, 0x3fb8aa3b, v209
    v_exp_f32 v209, v209
    v_sub_f32 v210, v210, v218
    v_mul_f32 v210, 0x3fb8aa3b, v210
    v_exp_f32 v210, v210
    v_sub_f32 v211, v211, v218
    v_mul_f32 v211, 0x3fb8aa3b, v211
    v_exp_f32 v211, v211
    v_sub_f32 v212, v212, v218
    v_mul_f32 v212, 0x3fb8aa3b, v212
    v_exp_f32 v212, v212
    v_sub_f32 v213, v213, v218
    v_mul_f32 v213, 0x3fb8aa3b, v213
    v_exp_f32 v213, v213
    v_sub_f32 v214, v214, v218
    v_mul_f32 v214, 0x3fb8aa3b, v214
    v_exp_f32 v214, v214
    v_sub_f32 v215, v215, v218
    v_mul_f32 v215, 0x3fb8aa3b, v215
    v_exp_f32 v215, v215
    s_nop 0
    v_add_f32 v219, v208, v209
    v_add_f32 v219, v219, v210
    v_add_f32 v219, v219, v211
    v_add_f32 v219, v219, v212
    v_add_f32 v219, v219, v213
    v_add_f32 v219, v219, v214
    v_add_f32 v219, v219, v215
    v_mov_b32 v216, v219
    s_nop 1
    v_permlane16_swap_b32 v219, v216
    s_nop 1
    v_add_f32 v219, v219, v216
    v_mov_b32 v216, v219
    s_nop 1
    v_permlane32_swap_b32 v219, v216
    s_nop 1
    v_add_f32 v219, v219, v216
    v_cvt_pk_bf16_f32 v220, v208, v209
    v_cvt_pk_bf16_f32 v221, v210, v211
    v_cvt_pk_bf16_f32 v222, v212, v213
    v_cvt_pk_bf16_f32 v223, v214, v215
    s_waitcnt vmcnt(0)
    v_perm_b32 v144, v116, v112, s78
    v_perm_b32 v145, v124, v120, s78
    v_perm_b32 v146, v132, v128, s78
    v_perm_b32 v147, v140, v136, s78
    v_perm_b32 v148, v116, v112, s79
    v_perm_b32 v149, v124, v120, s79
    v_perm_b32 v150, v132, v128, s79
    v_perm_b32 v151, v140, v136, s79
    s_nop 1
    v_mfma_f32_16x16x32_bf16 v[152:155], v[220:223], v[144:147], 0
    v_mfma_f32_16x16x32_bf16 v[156:159], v[220:223], v[148:151], 0
    v_perm_b32 v144, v117, v113, s78
    v_perm_b32 v145, v125, v121, s78
    v_perm_b32 v146, v133, v129, s78
    v_perm_b32 v147, v141, v137, s78
    v_perm_b32 v148, v117, v113, s79
    v_perm_b32 v149, v125, v121, s79
    v_perm_b32 v150, v133, v129, s79
    v_perm_b32 v151, v141, v137, s79
    s_nop 1
    v_mfma_f32_16x16x32_bf16 v[160:163], v[220:223], v[144:147], 0
    v_mfma_f32_16x16x32_bf16 v[164:167], v[220:223], v[148:151], 0
    v_perm_b32 v144, v118, v114, s78
    v_perm_b32 v145, v126, v122, s78
    v_perm_b32 v146, v134, v130, s78
    v_perm_b32 v147, v142, v138, s78
    v_perm_b32 v148, v118, v114, s79
    v_perm_b32 v149, v126, v122, s79
    v_perm_b32 v150, v134, v130, s79
    v_perm_b32 v151, v142, v138, s79
    s_nop 1
    v_mfma_f32_16x16x32_bf16 v[168:171], v[220:223], v[144:147], 0
    v_mfma_f32_16x16x32_bf16 v[172:175], v[220:223], v[148:151], 0
    v_perm_b32 v144, v119, v115, s78
    v_perm_b32 v145, v127, v123, s78
    v_perm_b32 v146, v135, v131, s78
    v_perm_b32 v147, v143, v139, s78
    v_perm_b32 v148, v119, v115, s79
    v_perm_b32 v149, v127, v123, s79
    v_perm_b32 v150, v135, v131, s79
    v_perm_b32 v151, v143, v139, s79
    s_nop 1
    v_mfma_f32_16x16x32_bf16 v[176:179], v[220:223], v[144:147], 0
    v_mfma_f32_16x16x32_bf16 v[180:183], v[220:223], v[148:151], 0
    s_lshl_b32 s4, s3, 11
    v_lshlrev_b32 v1, 5, v0
    v_add_u32 v1, s4, v1
    s_lshl_b32 s4, s3, 5
    v_lshlrev_b32 v2, 3, v0
    v_add_u32 v2, s4, v2
    s_nop 7
    v_mov_b32 v80, v152
    v_mov_b32 v81, v156
    v_mov_b32 v82, v160
    v_mov_b32 v83, v164
    v_mov_b32 v84, v168
    v_mov_b32 v85, v172
    v_mov_b32 v86, v176
    v_mov_b32 v87, v180
    v_mov_b32 v88, v153
    v_mov_b32 v89, v157
    v_mov_b32 v90, v161
    v_mov_b32 v91, v165
    v_mov_b32 v92, v169
    v_mov_b32 v93, v173
    v_mov_b32 v94, v177
    v_mov_b32 v95, v181
    v_mov_b32 v96, v154
    v_mov_b32 v97, v158
    v_mov_b32 v98, v162
    v_mov_b32 v99, v166
    v_mov_b32 v100, v170
    v_mov_b32 v101, v174
    v_mov_b32 v102, v178
    v_mov_b32 v103, v182
    v_mov_b32 v104, v155
    v_mov_b32 v105, v159
    v_mov_b32 v106, v163
    v_mov_b32 v107, v167
    v_mov_b32 v108, v171
    v_mov_b32 v109, v175
    v_mov_b32 v110, v179
    v_mov_b32 v111, v183
    s_mov_b32 exec_lo, 0xffff
    s_mov_b32 exec_hi, 0
    ds_write_b128 v1, v[80:83] offset:9216
    ds_write_b128 v1, v[84:87] offset:9232
    ds_write_b128 v1, v[88:91] offset:9728
    ds_write_b128 v1, v[92:95] offset:9744
    ds_write_b128 v1, v[96:99] offset:10240
    ds_write_b128 v1, v[100:103] offset:10256
    ds_write_b128 v1, v[104:107] offset:10752
    ds_write_b128 v1, v[108:111] offset:10768
    s_mov_b64 exec, 15
    ds_write_b64 v2, v[218:219] offset:17408
    s_mov_b64 exec, -1
    s_waitcnt lgkmcnt(0)
    v_mov_b32 v192, 19844
    v_mov_b32 v193, 1
    s_mov_b64 exec, 1
    ds_add_u32 v192, v193
    s_mov_b64 exec, -1
    s_lshl_b32 s4, s3, 3
    v_mov_b32 v1, s4
    s_lshl_b32 s4, s3, 9
    v_and_b32 v2, 31, v0
    v_lshlrev_b32 v2, 4, v2
    v_add_u32 v2, s4, v2
    s_lshr_b32 s4, s2, 3
    s_lshl_b32 s4, s4, 2
    s_add_u32 s4, s4, s3
    s_and_b32 s5, s2, 7
    s_lshl_b32 s6, s4, 12
    s_lshl_b32 s7, s5, 7
    s_add_u32 s6, s6, s7
    s_add_u32 s6, s6, 442368
    s_lshl_b32 s4, s4, 3
    s_add_u32 s4, s4, s5
    s_lshl_b32 s4, s4, 7
    s_add_u32 s4, s4, 966656
    v_and_b32 v7, 7, v0
    v_lshlrev_b32 v7, 4, v7
    v_lshrrev_b32 v204, 3, v0
    v_lshl_add_u32 v7, v204, 10, v7
    v_mov_b32 v192, 19844
    s_mov_b32 s91, 4000000
L_lw2:
    ds_read_b32 v193, v192
    s_waitcnt lgkmcnt(0)
    v_readfirstlane_b32 s92, v193
    s_nop 1
    s_nop 1
    s_cmp_ge_u32 s92, 4
    s_cbranch_scc1 L_lwd2
    s_sub_u32 s91, s91, 1
    s_cmp_eq_u32 s91, 0
    s_cbranch_scc1 L_lwd2
    s_sleep 1
    s_branch L_lw2
L_lwd2:
    ds_read_b64 v[152:153], v1 offset:17408
    ds_read_b64 v[154:155], v1 offset:17440
    ds_read_b64 v[156:157], v1 offset:17472
    ds_read_b64 v[158:159], v1 offset:17504
    ds_read_b128 v[160:163], v2 offset:9216
    ds_read_b128 v[164:167], v2 offset:11264
    ds_read_b128 v[168:171], v2 offset:13312
    ds_read_b128 v[172:175], v2 offset:15360
    s_waitcnt lgkmcnt(0)
    v_max3_f32 v176, v152, v154, v156
    v_max_f32 v176, v176, v158
    v_sub_f32 v192, v152, v176
    v_mul_f32 v192, 0x3fb8aa3b, v192
    v_exp_f32 v192, v192
    v_sub_f32 v193, v154, v176
    v_mul_f32 v193, 0x3fb8aa3b, v193
    v_exp_f32 v193, v193
    v_sub_f32 v194, v156, v176
    v_mul_f32 v194, 0x3fb8aa3b, v194
    v_exp_f32 v194, v194
    v_sub_f32 v195, v158, v176
    v_mul_f32 v195, 0x3fb8aa3b, v195
    v_exp_f32 v195, v195
    s_nop 0
    v_mul_f32 v177, v192, v153
    v_mul_f32 v196, v192, v160
    v_mul_f32 v197, v192, v161
    v_mul_f32 v198, v192, v162
    v_mul_f32 v199, v192, v163
    v_fmac_f32 v177, v193, v155
    v_fmac_f32 v196, v193, v164
    v_fmac_f32 v197, v193, v165
    v_fmac_f32 v198, v193, v166
    v_fmac_f32 v199, v193, v167
    v_fmac_f32 v177, v194, v157
    v_fmac_f32 v196, v194, v168
    v_fmac_f32 v197, v194, v169
    v_fmac_f32 v198, v194, v170
    v_fmac_f32 v199, v194, v171
    v_fmac_f32 v177, v195, v159
    v_fmac_f32 v196, v195, v172
    v_fmac_f32 v197, v195, v173
    v_fmac_f32 v198, v195, v174
    v_fmac_f32 v199, v195, v175
    v_add_u32 v196, 0x200, v196
    v_add_u32 v197, 0x200, v197
    v_add_u32 v198, 0x200, v198
    v_add_u32 v199, 0x200, v199
    v_bfi_b32 v196, s96, v188, v196
    v_bfi_b32 v197, s96, v189, v197
    v_bfi_b32 v198, s96, v190, v198
    v_bfi_b32 v199, s96, v191, v199
    v_mov_b32 v178, 0
    v_mov_b32 v179, 0
    v_add_u32 v200, 0x200, v176
    v_add_u32 v201, 0x200, v177
    v_add_u32 v202, 0x200, v178
    v_add_u32 v203, 0x200, v179
    v_bfi_b32 v200, s96, v188, v200
    v_bfi_b32 v201, s96, v189, v201
    v_bfi_b32 v202, s96, v190, v202
    v_bfi_b32 v203, s96, v191, v203
    v_mov_b32 v1, 0
    s_mov_b32 exec_lo, -1
    s_mov_b32 exec_hi, 0
    buffer_store_dwordx4 v[196:199], v7, s[64:67], s6 offen sc1
    s_mov_b64 exec, 1
    buffer_store_dwordx4 v[200:203], v1, s[64:67], s4 offen sc1
    s_mov_b64 exec, -1
    s_nop 1
L_exit_d:
    s_endpgm
L_comm:
    s_setprio 2
    s_sub_u32 s3, s3, 4
    v_mov_b32 v7, 0
    buffer_load_dwordx2 v[186:187], v7, s[64:67], 0 offen offset:0 sc1
    s_mov_b32 s8, 0
    s_cmp_ge_u32 s3, 2
    s_cbranch_scc1 L_p1_noload
    s_cmp_eq_u32 s3, 1
    s_cbranch_scc1 L_p1_w1
    s_mov_b32 s56, s22
    s_and_b32 s57, s23, 0xffff
    s_mov_b32 s58, 4194304
    s_mov_b32 s59, 0x00020000
    s_mov_b32 s5, 8192
    s_lshr_b32 s6, s2, 6
    s_lshl_b32 s6, s6, 7
    s_and_b32 s7, s2, 63
    s_lshl_b32 s7, s7, 7
    s_mov_b32 s8, 1
    s_branch L_p1_go
L_p1_w1:
    s_cmp_ge_u32 s2, 112
    s_cbranch_scc1 L_p1_noload
    s_mov_b32 s56, s28
    s_and_b32 s57, s29, 0xffff
    s_mov_b32 s58, 1835008
    s_mov_b32 s59, 0x00020000
    s_mov_b32 s5, 3584
    s_and_b32 s6, s2, 3
    s_lshl_b32 s6, s6, 7
    s_lshr_b32 s7, s2, 2
    s_lshl_b32 s7, s7, 7
    s_mov_b32 s8, 2
L_p1_go:
    v_mul_lo_u32 v7, s5, v4
    v_lshl_add_u32 v7, v1, 4, v7
    s_mul_i32 s9, s6, s5
    s_add_u32 s9, s9, s7
    s_lshl_b32 s12, s6, 1
    s_mul_i32 s13, s5, 56
    buffer_load_dwordx4 v[16:19], v7, s[56:59], s9 offen nt
    s_add_u32 s9, s9, s5
    buffer_load_dwordx4 v[20:23], v7, s[56:59], s9 offen nt
    s_add_u32 s9, s9, s5
    buffer_load_dwordx4 v[24:27], v7, s[56:59], s9 offen nt
    s_add_u32 s9, s9, s5
    buffer_load_dwordx4 v[28:31], v7, s[56:59], s9 offen nt
    s_add_u32 s9, s9, s5
    buffer_load_dwordx4 v[32:35], v7, s[56:59], s9 offen nt
    s_add_u32 s9, s9, s5
    buffer_load_dwordx4 v[36:39], v7, s[56:59], s9 offen nt
    s_add_u32 s9, s9, s5
    buffer_load_dwordx4 v[40:43], v7, s[56:59], s9 offen nt
    s_add_u32 s9, s9, s5
    buffer_load_dwordx4 v[44:47], v7, s[56:59], s9 offen nt
    s_add_u32 s9, s9, s5
    s_add_u32 s9, s9, s13
    buffer_load_dwordx4 v[48:51], v7, s[56:59], s9 offen nt
    s_add_u32 s9, s9, s5
    buffer_load_dwordx4 v[52:55], v7, s[56:59], s9 offen nt
    s_add_u32 s9, s9, s5
    buffer_load_dwordx4 v[56:59], v7, s[56:59], s9 offen nt
    s_add_u32 s9, s9, s5
    buffer_load_dwordx4 v[60:63], v7, s[56:59], s9 offen nt
    s_add_u32 s9, s9, s5
    buffer_load_dwordx4 v[64:67], v7, s[56:59], s9 offen nt
    s_add_u32 s9, s9, s5
    buffer_load_dwordx4 v[68:71], v7, s[56:59], s9 offen nt
    s_add_u32 s9, s9, s5
    buffer_load_dwordx4 v[72:75], v7, s[56:59], s9 offen nt
    s_add_u32 s9, s9, s5
    buffer_load_dwordx4 v[76:79], v7, s[56:59], s9 offen nt
    buffer_load_dwordx4 v[96:99], v6, s[44:47], s12 offen
    buffer_load_dwordx4 v[100:103], v6, s[44:47], s12 offen offset:128
    v_lshlrev_b32 v1, 4, v0
    buffer_load_dwordx4 v[104:107], v1, s[44:47], 0 offen offset:0
    buffer_load_dwordx4 v[108:111], v1, s[44:47], 0 offen offset:1024
    buffer_load_dwordx4 v[112:115], v1, s[44:47], 0 offen offset:2048
    buffer_load_dwordx4 v[116:119], v1, s[44:47], 0 offen offset:3072
L_p1_noload:
    s_cmp_lg_u32 s3, 0
    s_cbranch_scc1 L_c_noz
    v_mov_b32 v1, 0
    v_lshlrev_b32 v7, 2, v0
    s_mov_b64 exec, 0xffff
    ds_write_b32 v7, v1 offset:19840
    s_mov_b64 exec, -1
    s_waitcnt lgkmcnt(0)
L_c_noz:
    s_barrier
L_skipb0:
    s_lshl_b32 s15, s3, 11
    s_add_u32 s15, s15, 4096
L_real_start:
    s_waitcnt vmcnt(0) lgkmcnt(0)
    v_readfirstlane_b32 s76, v186
    v_readfirstlane_b32 s77, v187
    s_nop 3
    s_add_u32 s76, s76, 1
    s_addc_u32 s77, s77, 0
    s_and_b32 s80, s76, 0x3ff
    s_bfe_u32 s81, s76, 0xa000a
    s_bfe_u32 s82, s76, 0xa0014
    s_lshr_b64 s[84:85], s[76:77], 30
    s_and_b32 s83, s84, 0x3ff
    v_mov_b32 v188, s80
    v_mov_b32 v189, s81
    v_mov_b32 v190, s82
    v_mov_b32 v191, s83
    s_cmp_eq_u32 s8, 0
    s_cbranch_scc1 L_secQ
L_secP1:
    v_mov_b32 v12, v96
    v_mov_b32 v224, v100
    v_mov_b32 v13, v97
    v_mov_b32 v225, v101
    v_mov_b32 v14, v98
    v_mov_b32 v226, v102
    v_mov_b32 v15, v99
    v_mov_b32 v227, v103
    s_cmp_eq_u32 s8, 1
    s_cbranch_scc1 L_p1_mm
    v_lshlrev_b32 v196, 16, v104
    v_and_b32 v197, 0xffff0000, v104
    v_add_f32 v192, v196, v197
    v_lshlrev_b32 v196, 16, v105
    v_and_b32 v197, 0xffff0000, v105
    v_add_f32 v192, v192, v196
    v_add_f32 v192, v192, v197
    v_lshlrev_b32 v196, 16, v106
    v_and_b32 v197, 0xffff0000, v106
    v_add_f32 v192, v192, v196
    v_add_f32 v192, v192, v197
    v_lshlrev_b32 v196, 16, v107
    v_and_b32 v197, 0xffff0000, v107
    v_add_f32 v192, v192, v196
    v_add_f32 v192, v192, v197
    v_lshlrev_b32 v196, 16, v108
    v_and_b32 v197, 0xffff0000, v108
    v_add_f32 v193, v196, v197
    v_lshlrev_b32 v196, 16, v109
    v_and_b32 v197, 0xffff0000, v109
    v_add_f32 v193, v193, v196
    v_add_f32 v193, v193, v197
    v_lshlrev_b32 v196, 16, v110
    v_and_b32 v197, 0xffff0000, v110
    v_add_f32 v193, v193, v196
    v_add_f32 v193, v193, v197
    v_lshlrev_b32 v196, 16, v111
    v_and_b32 v197, 0xffff0000, v111
    v_add_f32 v193, v193, v196
    v_add_f32 v193, v193, v197
    v_lshlrev_b32 v196, 16, v112
    v_and_b32 v197, 0xffff0000, v112
    v_add_f32 v194, v196, v197
    v_lshlrev_b32 v196, 16, v113
    v_and_b32 v197, 0xffff0000, v113
    v_add_f32 v194, v194, v196
    v_add_f32 v194, v194, v197
    v_lshlrev_b32 v196, 16, v114
    v_and_b32 v197, 0xffff0000, v114
    v_add_f32 v194, v194, v196
    v_add_f32 v194, v194, v197
    v_lshlrev_b32 v196, 16, v115
    v_and_b32 v197, 0xffff0000, v115
    v_add_f32 v194, v194, v196
    v_add_f32 v194, v194, v197
    v_lshlrev_b32 v196, 16, v116
    v_and_b32 v197, 0xffff0000, v116
    v_add_f32 v195, v196, v197
    v_lshlrev_b32 v196, 16, v117
    v_and_b32 v197, 0xffff0000, v117
    v_add_f32 v195, v195, v196
    v_add_f32 v195, v195, v197
    v_lshlrev_b32 v196, 16, v118
    v_and_b32 v197, 0xffff0000, v118
    v_add_f32 v195, v195, v196
    v_add_f32 v195, v195, v197
    v_lshlrev_b32 v196, 16, v119
    v_and_b32 v197, 0xffff0000, v119
    v_add_f32 v195, v195, v196
    v_add_f32 v195, v195, v197
    s_nop 1
    v_add_f32_dpp v192, v192, v192 quad_perm:[1,0,3,2] row_mask:0xf bank_mask:0xf
    v_add_f32_dpp v193, v193, v193 quad_perm:[1,0,3,2] row_mask:0xf bank_mask:0xf
    v_add_f32_dpp v194, v194, v194 quad_perm:[1,0,3,2] row_mask:0xf bank_mask:0xf
    v_add_f32_dpp v195, v195, v195 quad_perm:[1,0,3,2] row_mask:0xf bank_mask:0xf
    s_nop 1
    v_add_f32_dpp v192, v192, v192 quad_perm:[2,3,0,1] row_mask:0xf bank_mask:0xf
    v_add_f32_dpp v193, v193, v193 quad_perm:[2,3,0,1] row_mask:0xf bank_mask:0xf
    v_add_f32_dpp v194, v194, v194 quad_perm:[2,3,0,1] row_mask:0xf bank_mask:0xf
    v_add_f32_dpp v195, v195, v195 quad_perm:[2,3,0,1] row_mask:0xf bank_mask:0xf
    s_nop 1
    v_add_f32_dpp v192, v192, v192 row_half_mirror row_mask:0xf bank_mask:0xf
    v_add_f32_dpp v193, v193, v193 row_half_mirror row_mask:0xf bank_mask:0xf
    v_add_f32_dpp v194, v194, v194 row_half_mirror row_mask:0xf bank_mask:0xf
    v_add_f32_dpp v195, v195, v195 row_half_mirror row_mask:0xf bank_mask:0xf
    s_nop 1
    v_add_f32_dpp v192, v192, v192 row_mirror row_mask:0xf bank_mask:0xf
    v_add_f32_dpp v193, v193, v193 row_mirror row_mask:0xf bank_mask:0xf
    v_add_f32_dpp v194, v194, v194 row_mirror row_mask:0xf bank_mask:0xf
    v_add_f32_dpp v195, v195, v195 row_mirror row_mask:0xf bank_mask:0xf
    v_mov_b32 v196, v192
    v_mov_b32 v197, v193
    v_mov_b32 v198, v194
    v_mov_b32 v199, v195
    s_nop 1
    v_permlane16_swap_b32 v192, v196
    v_permlane16_swap_b32 v193, v197
    v_permlane16_swap_b32 v194, v198
    v_permlane16_swap_b32 v195, v199
    s_nop 1
    v_add_f32 v192, v192, v196
    v_add_f32 v193, v193, v197
    v_add_f32 v194, v194, v198
    v_add_f32 v195, v195, v199
    v_mov_b32 v196, v192
    v_mov_b32 v197, v193
    v_mov_b32 v198, v194
    v_mov_b32 v199, v195
    s_nop 1
    v_permlane32_swap_b32 v192, v196
    v_permlane32_swap_b32 v193, v197
    v_permlane32_swap_b32 v194, v198
    v_permlane32_swap_b32 v195, v199
    s_nop 1
    v_add_f32 v192, v192, v196
    v_add_f32 v193, v193, v197
    v_add_f32 v194, v194, v198
    v_add_f32 v195, v195, v199
    v_mul_f32 v192, 0x3b000000, v192
    v_mul_f32 v193, 0x3b000000, v193
    v_mul_f32 v194, 0x3b000000, v194
    v_mul_f32 v195, 0x3b000000, v195
    v_lshlrev_b32 v196, 16, v104
    v_and_b32 v197, 0xffff0000, v104
    v_sub_f32 v196, v196, v192
    v_sub_f32 v197, v197, v192
    v_mul_f32 v204, v196, v196
    v_fmac_f32 v204, v197, v197
    v_lshlrev_b32 v196, 16, v105
    v_and_b32 v197, 0xffff0000, v105
    v_sub_f32 v196, v196, v192
    v_sub_f32 v197, v197, v192
    v_fmac_f32 v204, v196, v196
    v_fmac_f32 v204, v197, v197
    v_lshlrev_b32 v196, 16, v106
    v_and_b32 v197, 0xffff0000, v106
    v_sub_f32 v196, v196, v192
    v_sub_f32 v197, v197, v192
    v_fmac_f32 v204, v196, v196
    v_fmac_f32 v204, v197, v197
    v_lshlrev_b32 v196, 16, v107
    v_and_b32 v197, 0xffff0000, v107
    v_sub_f32 v196, v196, v192
    v_sub_f32 v197, v197, v192
    v_fmac_f32 v204, v196, v196
    v_fmac_f32 v204, v197, v197
    v_lshlrev_b32 v196, 16, v108
    v_and_b32 v197, 0xffff0000, v108
    v_sub_f32 v196, v196, v193
    v_sub_f32 v197, v197, v193
    v_mul_f32 v205, v196, v196
    v_fmac_f32 v205, v197, v197
    v_lshlrev_b32 v196, 16, v109
    v_and_b32 v197, 0xffff0000, v109
    v_sub_f32 v196, v196, v193
    v_sub_f32 v197, v197, v193
    v_fmac_f32 v205, v196, v196
    v_fmac_f32 v205, v197, v197
    v_lshlrev_b32 v196, 16, v110
    v_and_b32 v197, 0xffff0000, v110
    v_sub_f32 v196, v196, v193
    v_sub_f32 v197, v197, v193
    v_fmac_f32 v205, v196, v196
    v_fmac_f32 v205, v197, v197
    v_lshlrev_b32 v196, 16, v111
    v_and_b32 v197, 0xffff0000, v111
    v_sub_f32 v196, v196, v193
    v_sub_f32 v197, v197, v193
    v_fmac_f32 v205, v196, v196
    v_fmac_f32 v205, v197, v197
    v_lshlrev_b32 v196, 16, v112
    v_and_b32 v197, 0xffff0000, v112
    v_sub_f32 v196, v196, v194
    v_sub_f32 v197, v197, v194
    v_mul_f32 v206, v196, v196
    v_fmac_f32 v206, v197, v197
    v_lshlrev_b32 v196, 16, v113
    v_and_b32 v197, 0xffff0000, v113
    v_sub_f32 v196, v196, v194
    v_sub_f32 v197, v197, v194
    v_fmac_f32 v206, v196, v196
    v_fmac_f32 v206, v197, v197
    v_lshlrev_b32 v196, 16, v114
    v_and_b32 v197, 0xffff0000, v114
    v_sub_f32 v196, v196, v194
    v_sub_f32 v197, v197, v194
    v_fmac_f32 v206, v196, v196
    v_fmac_f32 v206, v197, v197
    v_lshlrev_b32 v196, 16, v115
    v_and_b32 v197, 0xffff0000, v115
    v_sub_f32 v196, v196, v194
    v_sub_f32 v197, v197, v194
    v_fmac_f32 v206, v196, v196
    v_fmac_f32 v206, v197, v197
    v_lshlrev_b32 v196, 16, v116
    v_and_b32 v197, 0xffff0000, v116
    v_sub_f32 v196, v196, v195
    v_sub_f32 v197, v197, v195
    v_mul_f32 v207, v196, v196
    v_fmac_f32 v207, v197, v197
    v_lshlrev_b32 v196, 16, v117
    v_and_b32 v197, 0xffff0000, v117
    v_sub_f32 v196, v196, v195
    v_sub_f32 v197, v197, v195
    v_fmac_f32 v207, v196, v196
    v_fmac_f32 v207, v197, v197
    v_lshlrev_b32 v196, 16, v118
    v_and_b32 v197, 0xffff0000, v118
    v_sub_f32 v196, v196, v195
    v_sub_f32 v197, v197, v195
    v_fmac_f32 v207, v196, v196
    v_fmac_f32 v207, v197, v197
    v_lshlrev_b32 v196, 16, v119
    v_and_b32 v197, 0xffff0000, v119
    v_sub_f32 v196, v196, v195
    v_sub_f32 v197, v197, v195
    v_fmac_f32 v207, v196, v196
    v_fmac_f32 v207, v197, v197
    s_nop 1
    v_add_f32_dpp v204, v204, v204 quad_perm:[1,0,3,2] row_mask:0xf bank_mask:0xf
    v_add_f32_dpp v205, v205, v205 quad_perm:[1,0,3,2] row_mask:0xf bank_mask:0xf
    v_add_f32_dpp v206, v206, v206 quad_perm:[1,0,3,2] row_mask:0xf bank_mask:0xf
    v_add_f32_dpp v207, v207, v207 quad_perm:[1,0,3,2] row_mask:0xf bank_mask:0xf
    s_nop 1
    v_add_f32_dpp v204, v204, v204 quad_perm:[2,3,0,1] row_mask:0xf bank_mask:0xf
    v_add_f32_dpp v205, v205, v205 quad_perm:[2,3,0,1] row_mask:0xf bank_mask:0xf
    v_add_f32_dpp v206, v206, v206 quad_perm:[2,3,0,1] row_mask:0xf bank_mask:0xf
    v_add_f32_dpp v207, v207, v207 quad_perm:[2,3,0,1] row_mask:0xf bank_mask:0xf
    s_nop 1
    v_add_f32_dpp v204, v204, v204 row_half_mirror row_mask:0xf bank_mask:0xf
    v_add_f32_dpp v205, v205, v205 row_half_mirror row_mask:0xf bank_mask:0xf
    v_add_f32_dpp v206, v206, v206 row_half_mirror row_mask:0xf bank_mask:0xf
    v_add_f32_dpp v207, v207, v207 row_half_mirror row_mask:0xf bank_mask:0xf
    s_nop 1
    v_add_f32_dpp v204, v204, v204 row_mirror row_mask:0xf bank_mask:0xf
    v_add_f32_dpp v205, v205, v205 row_mirror row_mask:0xf bank_mask:0xf
    v_add_f32_dpp v206, v206, v206 row_mirror row_mask:0xf bank_mask:0xf
    v_add_f32_dpp v207, v207, v207 row_mirror row_mask:0xf bank_mask:0xf
    v_mov_b32 v196, v204
    v_mov_b32 v197, v205
    v_mov_b32 v198, v206
    v_mov_b32 v199, v207
    s_nop 1
    v_permlane16_swap_b32 v204, v196
    v_permlane16_swap_b32 v205, v197
    v_permlane16_swap_b32 v206, v198
    v_permlane16_swap_b32 v207, v199
    s_nop 1
    v_add_f32 v204, v204, v196
    v_add_f32 v205, v205, v197
    v_add_f32 v206, v206, v198
    v_add_f32 v207, v207, v199
    v_mov_b32 v196, v204
    v_mov_b32 v197, v205
    v_mov_b32 v198, v206
    v_mov_b32 v199, v207
    s_nop 1
    v_permlane32_swap_b32 v204, v196
    v_permlane32_swap_b32 v205, v197
    v_permlane32_swap_b32 v206, v198
    v_permlane32_swap_b32 v207, v199
    s_nop 1
    v_add_f32 v204, v204, v196
    v_add_f32 v205, v205, v197
    v_add_f32 v206, v206, v198
    v_add_f32 v207, v207, v199
    v_mul_f32 v204, 0x3b000000, v204
    v_mul_f32 v205, 0x3b000000, v205
    v_mul_f32 v206, 0x3b000000, v206
    v_mul_f32 v207, 0x3b000000, v207
    v_mov_b32 v208, v192
    v_mov_b32 v209, v204
    v_cmp_eq_u32 vcc, 1, v5
    s_nop 1
    v_cndmask_b32 v208, v208, v193, vcc
    v_cndmask_b32 v209, v209, v205, vcc
    v_cmp_eq_u32 vcc, 2, v5
    s_nop 1
    v_cndmask_b32 v208, v208, v194, vcc
    v_cndmask_b32 v209, v209, v206, vcc
    v_cmp_eq_u32 vcc, 3, v5
    s_nop 1
    v_cndmask_b32 v208, v208, v195, vcc
    v_cndmask_b32 v209, v209, v207, vcc
    v_cvt_pk_bf16_f32 v196, v208, v209
    v_lshlrev_b32 v208, 16, v196
    v_and_b32 v209, 0xffff0000, v196
    v_add_f32 v209, 0x3727c5ac, v209
    v_cvt_pk_bf16_f32 v196, v209, v209
    v_lshlrev_b32 v209, 16, v196
    v_sqrt_f32 v209, v209
    s_nop 0
    v_cvt_pk_bf16_f32 v196, v209, v209
    v_lshlrev_b32 v209, 16, v196
    v_rcp_f32 v210, v209
    s_nop 0
    v_lshlrev_b32 v198, 16, v12
    v_and_b32 v199, 0xffff0000, v12
    v_sub_f32 v198, v198, v208
    v_sub_f32 v199, v199, v208
    v_cvt_pk_bf16_f32 v196, v198, v199
    v_lshlrev_b32 v198, 16, v196
    v_and_b32 v199, 0xffff0000, v196
    v_mul_f32 v200, v198, v210
    v_fma_f32 v201, -v200, v209, v198
    v_fma_f32 v198, v201, v210, v200
    v_mul_f32 v200, v199, v210
    v_fma_f32 v201, -v200, v209, v199
    v_fma_f32 v199, v201, v210, v200
    v_cvt_pk_bf16_f32 v12, v198, v199
    v_lshlrev_b32 v198, 16, v13
    v_and_b32 v199, 0xffff0000, v13
    v_sub_f32 v198, v198, v208
    v_sub_f32 v199, v199, v208
    v_cvt_pk_bf16_f32 v196, v198, v199
    v_lshlrev_b32 v198, 16, v196
    v_and_b32 v199, 0xffff0000, v196
    v_mul_f32 v200, v198, v210
    v_fma_f32 v201, -v200, v209, v198
    v_fma_f32 v198, v201, v210, v200
    v_mul_f32 v200, v199, v210
    v_fma_f32 v201, -v200, v209, v199
    v_fma_f32 v199, v201, v210, v200
    v_cvt_pk_bf16_f32 v13, v198, v199
    v_lshlrev_b32 v198, 16, v14
    v_and_b32 v199, 0xffff0000, v14
    v_sub_f32 v198, v198, v208
    v_sub_f32 v199, v199, v208
    v_cvt_pk_bf16_f32 v196, v198, v199
    v_lshlrev_b32 v198, 16, v196
    v_and_b32 v199, 0xffff0000, v196
    v_mul_f32 v200, v198, v210
    v_fma_f32 v201, -v200, v209, v198
    v_fma_f32 v198, v201, v210, v200
    v_mul_f32 v200, v199, v210
    v_fma_f32 v201, -v200, v209, v199
    v_fma_f32 v199, v201, v210, v200
    v_cvt_pk_bf16_f32 v14, v198, v199
    v_lshlrev_b32 v198, 16, v15
    v_and_b32 v199, 0xffff0000, v15
    v_sub_f32 v198, v198, v208
    v_sub_f32 v199, v199, v208
    v_cvt_pk_bf16_f32 v196, v198, v199
    v_lshlrev_b32 v198, 16, v196
    v_and_b32 v199, 0xffff0000, v196
    v_mul_f32 v200, v198, v210
    v_fma_f32 v201, -v200, v209, v198
    v_fma_f32 v198, v201, v210, v200
    v_mul_f32 v200, v199, v210
    v_fma_f32 v201, -v200, v209, v199
    v_fma_f32 v199, v201, v210, v200
    v_cvt_pk_bf16_f32 v15, v198, v199
    v_lshlrev_b32 v198, 16, v224
    v_and_b32 v199, 0xffff0000, v224
    v_sub_f32 v198, v198, v208
    v_sub_f32 v199, v199, v208
    v_cvt_pk_bf16_f32 v196, v198, v199
    v_lshlrev_b32 v198, 16, v196
    v_and_b32 v199, 0xffff0000, v196
    v_mul_f32 v200, v198, v210
    v_fma_f32 v201, -v200, v209, v198
    v_fma_f32 v198, v201, v210, v200
    v_mul_f32 v200, v199, v210
    v_fma_f32 v201, -v200, v209, v199
    v_fma_f32 v199, v201, v210, v200
    v_cvt_pk_bf16_f32 v224, v198, v199
    v_lshlrev_b32 v198, 16, v225
    v_and_b32 v199, 0xffff0000, v225
    v_sub_f32 v198, v198, v208
    v_sub_f32 v199, v199, v208
    v_cvt_pk_bf16_f32 v196, v198, v199
    v_lshlrev_b32 v198, 16, v196
    v_and_b32 v199, 0xffff0000, v196
    v_mul_f32 v200, v198, v210
    v_fma_f32 v201, -v200, v209, v198
    v_fma_f32 v198, v201, v210, v200
    v_mul_f32 v200, v199, v210
    v_fma_f32 v201, -v200, v209, v199
    v_fma_f32 v199, v201, v210, v200
    v_cvt_pk_bf16_f32 v225, v198, v199
    v_lshlrev_b32 v198, 16, v226
    v_and_b32 v199, 0xffff0000, v226
    v_sub_f32 v198, v198, v208
    v_sub_f32 v199, v199, v208
    v_cvt_pk_bf16_f32 v196, v198, v199
    v_lshlrev_b32 v198, 16, v196
    v_and_b32 v199, 0xffff0000, v196
    v_mul_f32 v200, v198, v210
    v_fma_f32 v201, -v200, v209, v198
    v_fma_f32 v198, v201, v210, v200
    v_mul_f32 v200, v199, v210
    v_fma_f32 v201, -v200, v209, v199
    v_fma_f32 v199, v201, v210, v200
    v_cvt_pk_bf16_f32 v226, v198, v199
    v_lshlrev_b32 v198, 16, v227
    v_and_b32 v199, 0xffff0000, v227
    v_sub_f32 v198, v198, v208
    v_sub_f32 v199, v199, v208
    v_cvt_pk_bf16_f32 v196, v198, v199
    v_lshlrev_b32 v198, 16, v196
    v_and_b32 v199, 0xffff0000, v196
    v_mul_f32 v200, v198, v210
    v_fma_f32 v201, -v200, v209, v198
    v_fma_f32 v198, v201, v210, v200
    v_mul_f32 v200, v199, v210
    v_fma_f32 v201, -v200, v209, v199
    v_fma_f32 v199, v201, v210, v200
    v_cvt_pk_bf16_f32 v227, v198, v199
L_p1_mm:
    v_perm_b32 v144, v20, v16, s78
    v_perm_b32 v145, v28, v24, s78
    v_perm_b32 v146, v36, v32, s78
    v_perm_b32 v147, v44, v40, s78
    v_perm_b32 v148, v20, v16, s79
    v_perm_b32 v149, v28, v24, s79
    v_perm_b32 v150, v36, v32, s79
    v_perm_b32 v151, v44, v40, s79
    s_nop 1
    v_mfma_f32_16x16x32_bf16 v[152:155], v[12:15], v[144:147], 0
    v_mfma_f32_16x16x32_bf16 v[156:159], v[12:15], v[148:151], 0
    v_perm_b32 v144, v21, v17, s78
    v_perm_b32 v145, v29, v25, s78
    v_perm_b32 v146, v37, v33, s78
    v_perm_b32 v147, v45, v41, s78
    v_perm_b32 v148, v21, v17, s79
    v_perm_b32 v149, v29, v25, s79
    v_perm_b32 v150, v37, v33, s79
    v_perm_b32 v151, v45, v41, s79
    s_nop 1
    v_mfma_f32_16x16x32_bf16 v[160:163], v[12:15], v[144:147], 0
    v_mfma_f32_16x16x32_bf16 v[164:167], v[12:15], v[148:151], 0
    v_perm_b32 v144, v22, v18, s78
    v_perm_b32 v145, v30, v26, s78
    v_perm_b32 v146, v38, v34, s78
    v_perm_b32 v147, v46, v42, s78
    v_perm_b32 v148, v22, v18, s79
    v_perm_b32 v149, v30, v26, s79
    v_perm_b32 v150, v38, v34, s79
    v_perm_b32 v151, v46, v42, s79
    s_nop 1
    v_mfma_f32_16x16x32_bf16 v[168:171], v[12:15], v[144:147], 0
    v_mfma_f32_16x16x32_bf16 v[172:175], v[12:15], v[148:151], 0
    v_perm_b32 v144, v23, v19, s78
    v_perm_b32 v145, v31, v27, s78
    v_perm_b32 v146, v39, v35, s78
    v_perm_b32 v147, v47, v43, s78
    v_perm_b32 v148, v23, v19, s79
    v_perm_b32 v149, v31, v27, s79
    v_perm_b32 v150, v39, v35, s79
    v_perm_b32 v151, v47, v43, s79
    s_nop 1
    v_mfma_f32_16x16x32_bf16 v[176:179], v[12:15], v[144:147], 0
    v_mfma_f32_16x16x32_bf16 v[180:183], v[12:15], v[148:151], 0
    v_perm_b32 v144, v52, v48, s78
    v_perm_b32 v145, v60, v56, s78
    v_perm_b32 v146, v68, v64, s78
    v_perm_b32 v147, v76, v72, s78
    v_perm_b32 v148, v52, v48, s79
    v_perm_b32 v149, v60, v56, s79
    v_perm_b32 v150, v68, v64, s79
    v_perm_b32 v151, v76, v72, s79
    s_nop 1
    v_mfma_f32_16x16x32_bf16 v[152:155], v[224:227], v[144:147], v[152:155]
    v_mfma_f32_16x16x32_bf16 v[156:159], v[224:227], v[148:151], v[156:159]
    v_perm_b32 v144, v53, v49, s78
    v_perm_b32 v145, v61, v57, s78
    v_perm_b32 v146, v69, v65, s78
    v_perm_b32 v147, v77, v73, s78
    v_perm_b32 v148, v53, v49, s79
    v_perm_b32 v149, v61, v57, s79
    v_perm_b32 v150, v69, v65, s79
    v_perm_b32 v151, v77, v73, s79
    s_nop 1
    v_mfma_f32_16x16x32_bf16 v[160:163], v[224:227], v[144:147], v[160:163]
    v_mfma_f32_16x16x32_bf16 v[164:167], v[224:227], v[148:151], v[164:167]
    v_perm_b32 v144, v54, v50, s78
    v_perm_b32 v145, v62, v58, s78
    v_perm_b32 v146, v70, v66, s78
    v_perm_b32 v147, v78, v74, s78
    v_perm_b32 v148, v54, v50, s79
    v_perm_b32 v149, v62, v58, s79
    v_perm_b32 v150, v70, v66, s79
    v_perm_b32 v151, v78, v74, s79
    s_nop 1
    v_mfma_f32_16x16x32_bf16 v[168:171], v[224:227], v[144:147], v[168:171]
    v_mfma_f32_16x16x32_bf16 v[172:175], v[224:227], v[148:151], v[172:175]
    v_perm_b32 v144, v55, v51, s78
    v_perm_b32 v145, v63, v59, s78
    v_perm_b32 v146, v71, v67, s78
    v_perm_b32 v147, v79, v75, s78
    v_perm_b32 v148, v55, v51, s79
    v_perm_b32 v149, v63, v59, s79
    v_perm_b32 v150, v71, v67, s79
    v_perm_b32 v151, v79, v75, s79
    s_nop 1
    v_mfma_f32_16x16x32_bf16 v[176:179], v[224:227], v[144:147], v[176:179]
    v_mfma_f32_16x16x32_bf16 v[180:183], v[224:227], v[148:151], v[180:183]
    v_lshlrev_b32 v1, 4, v0
    v_lshrrev_b32 v200, 4, v0
    v_add_u32 v1, s15, v1
    v_add_u32 v2, s15, v10
    s_nop 7
    v_mov_b32 v120, v152
    v_mov_b32 v121, v156
    v_mov_b32 v122, v160
    v_mov_b32 v123, v164
    v_mov_b32 v124, v168
    v_mov_b32 v125, v172
    v_mov_b32 v126, v176
    v_mov_b32 v127, v180
    v_mov_b32 v128, v153
    v_mov_b32 v129, v157
    v_mov_b32 v130, v161
    v_mov_b32 v131, v165
    v_mov_b32 v132, v169
    v_mov_b32 v133, v173
    v_mov_b32 v134, v177
    v_mov_b32 v135, v181
    v_mov_b32 v136, v154
    v_mov_b32 v137, v158
    v_mov_b32 v138, v162
    v_mov_b32 v139, v166
    v_mov_b32 v140, v170
    v_mov_b32 v141, v174
    v_mov_b32 v142, v178
    v_mov_b32 v143, v182
    v_mov_b32 v144, v155
    v_mov_b32 v145, v159
    v_mov_b32 v146, v163
    v_mov_b32 v147, v167
    v_mov_b32 v148, v171
    v_mov_b32 v149, v175
    v_mov_b32 v150, v179
    v_mov_b32 v151, v183
    s_mov_b32 exec_lo, 0xff0000ff
    s_mov_b32 exec_hi, 0
    ds_write_b128 v2, v[120:123] offset:0
    ds_write_b128 v2, v[124:127] offset:16
    ds_write_b128 v2, v[128:131] offset:256
    ds_write_b128 v2, v[132:135] offset:272
    ds_write_b128 v2, v[136:139] offset:512
    ds_write_b128 v2, v[140:143] offset:528
    ds_write_b128 v2, v[144:147] offset:768
    ds_write_b128 v2, v[148:151] offset:784
    s_mov_b64 exec, -1
    s_waitcnt lgkmcnt(0)
    ds_read_b128 v[192:195], v1
    ds_read_b128 v[196:199], v1 offset:1024
    s_waitcnt lgkmcnt(0)
    v_add_f32 v192, v192, v196
    v_add_f32 v193, v193, v197
    v_add_f32 v194, v194, v198
    v_add_f32 v195, v195, v199
    v_add_u32 v192, 0x200, v192
    v_add_u32 v193, 0x200, v193
    v_add_u32 v194, 0x200, v194
    v_add_u32 v195, 0x200, v195
    v_bfi_b32 v192, s96, v188, v192
    v_bfi_b32 v193, s96, v189, v193
    v_bfi_b32 v194, s96, v190, v194
    v_bfi_b32 v195, s96, v191, v195
    v_and_b32 v1, 15, v0
    s_cmp_eq_u32 s8, 1
    s_cbranch_scc1 L_pub_q
    s_and_b32 s4, s2, 3
    s_mul_i32 s4, s4, 1792
    s_lshr_b32 s5, s2, 2
    s_lshl_b32 s5, s5, 4
    s_add_u32 s4, s4, s5
    s_lshl_b32 s4, s4, 4
    s_add_u32 s4, s4, 327680
    v_mul_u32_u24 v2, 448, v200
    v_add_u32 v1, v2, v1
    s_branch L_pub_go
L_pub_q:
    s_lshr_b32 s4, s2, 6
    s_lshl_b32 s4, s4, 12
    s_and_b32 s5, s2, 63
    s_lshl_b32 s5, s5, 4
    s_add_u32 s4, s4, s5
    s_lshl_b32 s4, s4, 4
    s_add_u32 s4, s4, 65536
    v_lshl_add_u32 v1, v200, 10, v1
L_pub_go:
    v_lshlrev_b32 v1, 4, v1
    s_nop 1
    buffer_store_dwordx4 v[192:195], v1, s[64:67], s4 offen sc1
    s_waitcnt vmcnt(0)
    s_cmp_eq_u32 s8, 1
    s_cbranch_scc0 L_nop2
    s_waitcnt lgkmcnt(0)
    v_mov_b32 v202, 19868
    v_mov_b32 v203, 1
    s_mov_b64 exec, 1
    ds_add_u32 v202, v203
    s_mov_b64 exec, -1
L_nop2:
L_secQ:
    v_lshlrev_b32 v3, 4, v0
    s_lshl_b32 s4, s3, 8
    v_and_b32 v5, 31, v0
    v_lshlrev_b32 v5, 3, v5
    v_add_u32 v5, s4, v5
    s_cmp_lt_u32 s3, 2
    s_cbranch_scc1 L_q_skip
    s_lshr_b32 s4, s2, 6
    s_lshl_b32 s4, s4, 10
    s_lshr_b32 s5, s2, 3
    s_and_b32 s5, s5, 7
    s_lshl_b32 s5, s5, 7
    s_add_u32 s4, s4, s5
    s_sub_u32 s5, s3, 2
    s_lshl_b32 s5, s5, 6
    s_add_u32 s4, s4, s5
    s_lshl_b32 s4, s4, 4
    s_add_u32 s4, s4, 65536
    s_add_u32 s5, s4, 65536
    s_add_u32 s6, s4, 131072
    s_add_u32 s7, s4, 196608
    v_mov_b32 v32, 19868
    s_mov_b32 s91, 4000000
L_lw3:
    ds_read_b32 v33, v32
    s_waitcnt lgkmcnt(0)
    v_readfirstlane_b32 s92, v33
    s_nop 1
    s_nop 1
    s_cmp_ge_u32 s92, 1
    s_cbranch_scc1 L_lwd3
    s_sub_u32 s91, s91, 1
    s_cmp_eq_u32 s91, 0
    s_cbranch_scc1 L_lwd3
    s_sleep 1
    s_branch L_lw3
L_lwd3:
    s_mov_b32 s90, 100000
L_poll_q:
    buffer_load_dwordx4 v[16:19], v3, s[64:67], s4 offen sc1
    buffer_load_dwordx4 v[20:23], v3, s[64:67], s5 offen sc1
    buffer_load_dwordx4 v[24:27], v3, s[64:67], s6 offen sc1
    buffer_load_dwordx4 v[28:31], v3, s[64:67], s7 offen sc1
    s_waitcnt vmcnt(0)
    v_xor_b32 v6, v16, v188
    v_xor_b32 v7, v17, v189
    v_or_b32 v6, v6, v7
    v_xor_b32 v7, v18, v190
    v_or_b32 v6, v6, v7
    v_xor_b32 v7, v19, v191
    v_or_b32 v6, v6, v7
    v_xor_b32 v7, v20, v188
    v_or_b32 v6, v6, v7
    v_xor_b32 v7, v21, v189
    v_or_b32 v6, v6, v7
    v_xor_b32 v7, v22, v190
    v_or_b32 v6, v6, v7
    v_xor_b32 v7, v23, v191
    v_or_b32 v6, v6, v7
    v_xor_b32 v7, v24, v188
    v_or_b32 v6, v6, v7
    v_xor_b32 v7, v25, v189
    v_or_b32 v6, v6, v7
    v_xor_b32 v7, v26, v190
    v_or_b32 v6, v6, v7
    v_xor_b32 v7, v27, v191
    v_or_b32 v6, v6, v7
    v_xor_b32 v7, v28, v188
    v_or_b32 v6, v6, v7
    v_xor_b32 v7, v29, v189
    v_or_b32 v6, v6, v7
    v_xor_b32 v7, v30, v190
    v_or_b32 v6, v6, v7
    v_xor_b32 v7, v31, v191
    v_or_b32 v6, v6, v7
    v_and_b32 v6, 0x3ff, v6
    v_cmp_ne_u32 vcc, 0, v6
    s_nop 1
    s_cmp_eq_u64 vcc, 0
    s_cbranch_scc1 L_pdone_q
    s_sub_u32 s90, s90, 1
    s_cmp_eq_u32 s90, 0
    s_cbranch_scc1 L_pdone_q
    s_sleep 1
    s_branch L_poll_q
L_pdone_q:
    v_and_b32 v16, 0xfffffc00, v16
    v_and_b32 v17, 0xfffffc00, v17
    v_and_b32 v18, 0xfffffc00, v18
    v_and_b32 v19, 0xfffffc00, v19
    v_and_b32 v20, 0xfffffc00, v20
    v_and_b32 v21, 0xfffffc00, v21
    v_and_b32 v22, 0xfffffc00, v22
    v_and_b32 v23, 0xfffffc00, v23
    v_and_b32 v24, 0xfffffc00, v24
    v_and_b32 v25, 0xfffffc00, v25
    v_and_b32 v26, 0xfffffc00, v26
    v_and_b32 v27, 0xfffffc00, v27
    v_and_b32 v28, 0xfffffc00, v28
    v_and_b32 v29, 0xfffffc00, v29
    v_and_b32 v30, 0xfffffc00, v30
    v_and_b32 v31, 0xfffffc00, v31
    v_add_f32 v32, v16, v20
    v_add_f32 v36, v24, v28
    v_add_f32 v33, v17, v21
    v_add_f32 v37, v25, v29
    v_add_f32 v34, v18, v22
    v_add_f32 v38, v26, v30
    v_add_f32 v35, v19, v23
    v_add_f32 v39, v27, v31
    v_add_f32 v32, v32, v36
    v_add_f32 v33, v33, v37
    v_add_f32 v34, v34, v38
    v_add_f32 v35, v35, v39
    v_cvt_pk_bf16_f32 v32, v32, v33
    v_cvt_pk_bf16_f32 v33, v34, v35
    s_sub_u32 s4, s3, 2
    s_lshl_b32 s4, s4, 9
    v_lshlrev_b32 v4, 3, v0
    v_add_u32 v4, s4, v4
    ds_write_b64 v4, v[32:33] offset:8192
    s_waitcnt lgkmcnt(0)
    v_mov_b32 v6, 19840
    v_mov_b32 v7, 1
    s_mov_b64 exec, 1
    ds_add_u32 v6, v7
    s_mov_b64 exec, -1
L_q_skip:
    s_mov_b32 s14, 0
    v_lshrrev_b32 v9, 4, v0
    s_cmp_lt_u32 s3, 2
    s_cbranch_scc1 L_nowo0
    s_mov_b32 s60, s24
    s_and_b32 s61, s25, 0xffff
    s_mov_b32 s62, 4194304
    s_mov_b32 s63, 0x00020000
    s_lshr_b32 s6, s2, 1
    s_lshl_b32 s9, s6, 15
    s_and_b32 s7, s2, 1
    s_lshl_b32 s7, s7, 9
    s_add_u32 s9, s9, s7
    s_sub_u32 s7, s3, 2
    s_lshl_b32 s7, s7, 8
    s_add_u32 s9, s9, s7
    v_and_b32 v7, 15, v0
    v_lshlrev_b32 v7, 4, v7
    v_lshl_add_u32 v7, v9, 13, v7
    buffer_load_dwordx4 v[96:99], v7, s[60:63], s9 offen offset:0 nt
    buffer_load_dwordx4 v[100:103], v7, s[60:63], s9 offen offset:1024 nt
    buffer_load_dwordx4 v[104:107], v7, s[60:63], s9 offen offset:2048 nt
    buffer_load_dwordx4 v[108:111], v7, s[60:63], s9 offen offset:3072 nt
    s_add_u32 s9, s9, 4096
    buffer_load_dwordx4 v[112:115], v7, s[60:63], s9 offen offset:0 nt
    buffer_load_dwordx4 v[116:119], v7, s[60:63], s9 offen offset:1024 nt
    buffer_load_dwordx4 v[120:123], v7, s[60:63], s9 offen offset:2048 nt
    buffer_load_dwordx4 v[124:127], v7, s[60:63], s9 offen offset:3072 nt
    s_branch L_now2
L_nowo0:
    s_cmp_eq_u32 s3, 1
    s_cbranch_scc0 L_now2
    s_cmp_lt_u32 s2, 112
    s_cbranch_scc1 L_now2
    s_cmp_ge_u32 s2, 224
    s_cbranch_scc1 L_now2
    s_mov_b32 s14, 1
    s_mov_b32 s60, s32
    s_and_b32 s61, s33, 0xffff
    s_mov_b32 s62, 1835008
    s_mov_b32 s63, 0x00020000
    s_sub_u32 s9, s2, 112
    s_lshr_b32 s6, s9, 3
    s_lshl_b32 s6, s6, 17
    s_and_b32 s7, s9, 7
    s_lshl_b32 s7, s7, 7
    s_add_u32 s9, s6, s7
    v_bfe_u32 v7, v0, 3, 1
    v_lshlrev_b32 v7, 5, v7
    v_lshl_add_u32 v9, v9, 3, v7
    v_and_b32 v7, 7, v0
    v_lshlrev_b32 v7, 4, v7
    v_lshl_add_u32 v7, v9, 10, v7
    buffer_load_dwordx4 v[96:99], v7, s[60:63], s9 offen offset:0 nt
    buffer_load_dwordx4 v[100:103], v7, s[60:63], s9 offen offset:1024 nt
    buffer_load_dwordx4 v[104:107], v7, s[60:63], s9 offen offset:2048 nt
    buffer_load_dwordx4 v[108:111], v7, s[60:63], s9 offen offset:3072 nt
    s_add_u32 s9, s9, 4096
    buffer_load_dwordx4 v[112:115], v7, s[60:63], s9 offen offset:0 nt
    buffer_load_dwordx4 v[116:119], v7, s[60:63], s9 offen offset:1024 nt
    buffer_load_dwordx4 v[120:123], v7, s[60:63], s9 offen offset:2048 nt
    buffer_load_dwordx4 v[124:127], v7, s[60:63], s9 offen offset:3072 nt
    s_add_u32 s9, s9, 61440
    buffer_load_dwordx4 v[128:131], v7, s[60:63], s9 offen offset:0 nt
    buffer_load_dwordx4 v[132:135], v7, s[60:63], s9 offen offset:1024 nt
    buffer_load_dwordx4 v[136:139], v7, s[60:63], s9 offen offset:2048 nt
    buffer_load_dwordx4 v[140:143], v7, s[60:63], s9 offen offset:3072 nt
    s_add_u32 s9, s9, 4096
    buffer_load_dwordx4 v[144:147], v7, s[60:63], s9 offen offset:0 nt
    buffer_load_dwordx4 v[148:151], v7, s[60:63], s9 offen offset:1024 nt
    buffer_load_dwordx4 v[152:155], v7, s[60:63], s9 offen offset:2048 nt
    buffer_load_dwordx4 v[156:159], v7, s[60:63], s9 offen offset:3072 nt
L_now2:
    s_lshr_b32 s4, s2, 4
    s_lshl_b32 s4, s4, 7
    s_and_b32 s5, s2, 15
    s_lshl_b32 s5, s5, 3
    s_add_u32 s4, s4, s5
    s_lshl_b32 s4, s4, 4
    s_add_u32 s4, s4, 1097728
    s_lshl_b32 s5, s3, 18
    s_add_u32 s86, s4, s5
    s_add_u32 s87, s86, 65536
    s_add_u32 s88, s86, 131072
    s_add_u32 s89, s86, 196608
    s_lshl_b32 s5, s3, 15
    s_add_u32 s5, s4, s5
    s_add_u32 s85, s5, 1048576
    v_and_b32 v60, 7, v0
    v_lshlrev_b32 v60, 4, v60
    v_lshrrev_b32 v61, 3, v0
    v_lshl_add_u32 v60, v61, 13, v60
    v_and_b32 v62, 3, v61
    s_lshl_b32 s5, s3, 2
    s_sub_u32 s5, 13, s5
    v_min_u32 v62, s5, v62
    v_and_b32 v63, 7, v0
    v_lshlrev_b32 v63, 4, v63
    v_lshl_add_u32 v62, v62, 13, v63
    s_cmp_ge_u32 s2, 64
    s_cbranch_scc1 L_c_nowarm
    buffer_load_dwordx4 v[32:35], v60, s[64:67], s86 offen sc1
    buffer_load_dwordx4 v[36:39], v60, s[64:67], s87 offen sc1
    buffer_load_dwordx4 v[40:43], v60, s[64:67], s88 offen sc1
    buffer_load_dwordx4 v[44:47], v60, s[64:67], s89 offen sc1
    buffer_load_dwordx4 v[48:51], v62, s[64:67], s85 offen sc1
    s_mov_b32 s72, s36
    s_and_b32 s73, s37, 0xffff
    s_mov_b32 s74, 1024
    s_mov_b32 s75, 0x00020000
    buffer_load_dwordx4 v[64:67], v3, s[72:75], 0 offen
    s_lshr_b32 s4, s2, 4
    s_lshl_b32 s4, s4, 10
    buffer_load_dwordx4 v[68:71], v3, s[44:47], s4 offen
    s_mov_b32 s68, s34
    s_and_b32 s69, s35, 0xffff
    s_mov_b32 s70, 1024
    s_mov_b32 s71, 0x00020000
    v_and_b32 v6, 31, v0
    v_lshlrev_b32 v6, 1, v6
    s_and_b32 s4, s2, 15
    s_lshl_b32 s4, s4, 6
    buffer_load_ushort v72, v6, s[68:71], s4 offen
L_c_nowarm:
    s_nop 1
    s_cmp_lt_u32 s2, 112
    s_cbranch_scc1 L_secAG
    s_cmp_ge_u32 s2, 224
    s_cbranch_scc1 L_secAG
L_secH:
    s_sub_u32 s9, s2, 112
    s_lshr_b32 s9, s9, 3
    s_min_u32 s9, s9, 13
    s_mul_i32 s4, s3, 448
    s_lshl_b32 s5, s9, 5
    s_add_u32 s4, s4, s5
    s_lshl_b32 s4, s4, 4
    s_add_u32 s4, s4, 327680
    s_add_u32 s5, s4, 28672
    s_mov_b32 s72, s30
    s_and_b32 s73, s31, 0xffff
    s_mov_b32 s74, 3584
    s_mov_b32 s75, 0x00020000
    s_lshl_b32 s9, s9, 8
    v_and_b32 v6, 31, v0
    v_lshlrev_b32 v4, 4, v6
    v_lshlrev_b32 v6, 3, v6
    buffer_load_dwordx2 v[80:81], v6, s[72:75], s9 offen
    v_lshrrev_b32 v7, 5, v0
    s_mov_b32 s6, 57344
    v_mul_lo_u32 v7, s6, v7
    v_add_u32 v4, v7, v4
    s_mov_b32 s90, 100000
L_poll_h:
    buffer_load_dwordx4 v[16:19], v4, s[64:67], s4 offen sc1
    buffer_load_dwordx4 v[20:23], v4, s[64:67], s5 offen sc1
    s_waitcnt vmcnt(0)
    v_xor_b32 v6, v16, v188
    v_xor_b32 v7, v17, v189
    v_or_b32 v6, v6, v7
    v_xor_b32 v7, v18, v190
    v_or_b32 v6, v6, v7
    v_xor_b32 v7, v19, v191
    v_or_b32 v6, v6, v7
    v_xor_b32 v7, v20, v188
    v_or_b32 v6, v6, v7
    v_xor_b32 v7, v21, v189
    v_or_b32 v6, v6, v7
    v_xor_b32 v7, v22, v190
    v_or_b32 v6, v6, v7
    v_xor_b32 v7, v23, v191
    v_or_b32 v6, v6, v7
    v_and_b32 v6, 0x3ff, v6
    v_cmp_ne_u32 vcc, 0, v6
    s_nop 1
    s_cmp_eq_u64 vcc, 0
    s_cbranch_scc1 L_pdone_h
    s_sub_u32 s90, s90, 1
    s_cmp_eq_u32 s90, 0
    s_cbranch_scc1 L_pdone_h
    s_sleep 1
    s_branch L_poll_h
L_pdone_h:
    v_and_b32 v16, 0xfffffc00, v16
    v_and_b32 v17, 0xfffffc00, v17
    v_and_b32 v18, 0xfffffc00, v18
    v_and_b32 v19, 0xfffffc00, v19
    v_and_b32 v20, 0xfffffc00, v20
    v_and_b32 v21, 0xfffffc00, v21
    v_and_b32 v22, 0xfffffc00, v22
    v_and_b32 v23, 0xfffffc00, v23
    v_add_f32 v24, v16, v20
    v_add_f32 v25, v17, v21
    v_add_f32 v26, v18, v22
    v_add_f32 v27, v19, v23
    v_mov_b32 v28, v24
    v_mov_b32 v29, v25
    v_mov_b32 v30, v26
    v_mov_b32 v31, v27
    s_nop 1
    v_permlane32_swap_b32 v24, v28
    v_permlane32_swap_b32 v25, v29
    v_permlane32_swap_b32 v26, v30
    v_permlane32_swap_b32 v27, v31
    s_nop 1
    v_add_f32 v24, v24, v28
    v_add_f32 v25, v25, v29
    v_add_f32 v26, v26, v30
    v_add_f32 v27, v27, v31
    v_cvt_pk_bf16_f32 v28, v24, v25
    v_lshlrev_b32 v24, 16, v28
    v_and_b32 v25, 0xffff0000, v28
    v_lshlrev_b32 v28, 16, v80
    v_and_b32 v29, 0xffff0000, v80
    v_add_f32 v24, v24, v28
    v_add_f32 v25, v25, v29
    v_cvt_pk_bf16_f32 v28, v24, v25
    v_lshlrev_b32 v24, 16, v28
    v_and_b32 v25, 0xffff0000, v28
    v_cvt_pk_bf16_f32 v28, v26, v27
    v_lshlrev_b32 v26, 16, v28
    v_and_b32 v27, 0xffff0000, v28
    v_lshlrev_b32 v28, 16, v81
    v_and_b32 v29, 0xffff0000, v81
    v_add_f32 v26, v26, v28
    v_add_f32 v27, v27, v29
    v_cvt_pk_bf16_f32 v28, v26, v27
    v_lshlrev_b32 v26, 16, v28
    v_and_b32 v27, 0xffff0000, v28
    v_mov_b32 v31, 0x3d372713
    v_mul_f32 v30, v24, v24
    v_mul_f32 v30, v30, v24
    v_fma_f32 v30, v30, v31, v24
    v_mul_f32 v30, 0x40135761, v30
    v_exp_f32 v30, v30
    s_nop 0
    v_add_f32 v30, 1.0, v30
    v_rcp_f32 v30, v30
    s_nop 0
    v_fma_f32 v30, v30, -2.0, 2.0
    v_mul_f32 v30, 0.5, v30
    v_mul_f32 v24, v24, v30
    v_mul_f32 v30, v25, v25
    v_mul_f32 v30, v30, v25
    v_fma_f32 v30, v30, v31, v25
    v_mul_f32 v30, 0x40135761, v30
    v_exp_f32 v30, v30
    s_nop 0
    v_add_f32 v30, 1.0, v30
    v_rcp_f32 v30, v30
    s_nop 0
    v_fma_f32 v30, v30, -2.0, 2.0
    v_mul_f32 v30, 0.5, v30
    v_mul_f32 v25, v25, v30
    v_mul_f32 v30, v26, v26
    v_mul_f32 v30, v30, v26
    v_fma_f32 v30, v30, v31, v26
    v_mul_f32 v30, 0x40135761, v30
    v_exp_f32 v30, v30
    s_nop 0
    v_add_f32 v30, 1.0, v30
    v_rcp_f32 v30, v30
    s_nop 0
    v_fma_f32 v30, v30, -2.0, 2.0
    v_mul_f32 v30, 0.5, v30
    v_mul_f32 v26, v26, v30
    v_mul_f32 v30, v27, v27
    v_mul_f32 v30, v30, v27
    v_fma_f32 v30, v30, v31, v27
    v_mul_f32 v30, 0x40135761, v30
    v_exp_f32 v30, v30
    s_nop 0
    v_add_f32 v30, 1.0, v30
    v_rcp_f32 v30, v30
    s_nop 0
    v_fma_f32 v30, v30, -2.0, 2.0
    v_mul_f32 v30, 0.5, v30
    v_mul_f32 v27, v27, v30
    v_cvt_pk_bf16_f32 v24, v24, v25
    v_cvt_pk_bf16_f32 v25, v26, v27
    ds_write_b64 v5, v[24:25] offset:17792
    s_waitcnt lgkmcnt(0)
    v_mov_b32 v6, 19848
    v_mov_b32 v7, 1
    s_mov_b64 exec, 1
    ds_add_u32 v6, v7
    s_mov_b64 exec, -1
    s_cmp_eq_u32 s14, 1
    s_cbranch_scc0 L_secAG
    v_mov_b32 v6, 19848
    s_mov_b32 s91, 4000000
L_lw4:
    ds_read_b32 v7, v6
    s_waitcnt lgkmcnt(0)
    v_readfirstlane_b32 s92, v7
    s_nop 1
    s_nop 1
    s_cmp_ge_u32 s92, 4
    s_cbranch_scc1 L_lwd4
    s_sub_u32 s91, s91, 1
    s_cmp_eq_u32 s91, 0
    s_cbranch_scc1 L_lwd4
    s_sleep 1
    s_branch L_lw4
L_lwd4:
    ds_read_b128 v[12:15], v11 offset:17792
    ds_read_b128 v[224:227], v11 offset:17920
    s_waitcnt vmcnt(0)
    s_waitcnt lgkmcnt(0)
    v_perm_b32 v160, v100, v96, s78
    v_perm_b32 v161, v108, v104, s78
    v_perm_b32 v162, v116, v112, s78
    v_perm_b32 v163, v124, v120, s78
    v_perm_b32 v164, v100, v96, s79
    v_perm_b32 v165, v108, v104, s79
    v_perm_b32 v166, v116, v112, s79
    v_perm_b32 v167, v124, v120, s79
    s_nop 1
    v_mfma_f32_16x16x32_bf16 v[16:19], v[12:15], v[160:163], 0
    v_mfma_f32_16x16x32_bf16 v[20:23], v[12:15], v[164:167], 0
    v_perm_b32 v160, v101, v97, s78
    v_perm_b32 v161, v109, v105, s78
    v_perm_b32 v162, v117, v113, s78
    v_perm_b32 v163, v125, v121, s78
    v_perm_b32 v164, v101, v97, s79
    v_perm_b32 v165, v109, v105, s79
    v_perm_b32 v166, v117, v113, s79
    v_perm_b32 v167, v125, v121, s79
    s_nop 1
    v_mfma_f32_16x16x32_bf16 v[24:27], v[12:15], v[160:163], 0
    v_mfma_f32_16x16x32_bf16 v[28:31], v[12:15], v[164:167], 0
    v_perm_b32 v160, v102, v98, s78
    v_perm_b32 v161, v110, v106, s78
    v_perm_b32 v162, v118, v114, s78
    v_perm_b32 v163, v126, v122, s78
    v_perm_b32 v164, v102, v98, s79
    v_perm_b32 v165, v110, v106, s79
    v_perm_b32 v166, v118, v114, s79
    v_perm_b32 v167, v126, v122, s79
    s_nop 1
    v_mfma_f32_16x16x32_bf16 v[32:35], v[12:15], v[160:163], 0
    v_mfma_f32_16x16x32_bf16 v[36:39], v[12:15], v[164:167], 0
    v_perm_b32 v160, v103, v99, s78
    v_perm_b32 v161, v111, v107, s78
    v_perm_b32 v162, v119, v115, s78
    v_perm_b32 v163, v127, v123, s78
    v_perm_b32 v164, v103, v99, s79
    v_perm_b32 v165, v111, v107, s79
    v_perm_b32 v166, v119, v115, s79
    v_perm_b32 v167, v127, v123, s79
    s_nop 1
    v_mfma_f32_16x16x32_bf16 v[40:43], v[12:15], v[160:163], 0
    v_mfma_f32_16x16x32_bf16 v[44:47], v[12:15], v[164:167], 0
    v_perm_b32 v160, v132, v128, s78
    v_perm_b32 v161, v140, v136, s78
    v_perm_b32 v162, v148, v144, s78
    v_perm_b32 v163, v156, v152, s78
    v_perm_b32 v164, v132, v128, s79
    v_perm_b32 v165, v140, v136, s79
    v_perm_b32 v166, v148, v144, s79
    v_perm_b32 v167, v156, v152, s79
    s_nop 1
    v_mfma_f32_16x16x32_bf16 v[16:19], v[224:227], v[160:163], v[16:19]
    v_mfma_f32_16x16x32_bf16 v[20:23], v[224:227], v[164:167], v[20:23]
    v_perm_b32 v160, v133, v129, s78
    v_perm_b32 v161, v141, v137, s78
    v_perm_b32 v162, v149, v145, s78
    v_perm_b32 v163, v157, v153, s78
    v_perm_b32 v164, v133, v129, s79
    v_perm_b32 v165, v141, v137, s79
    v_perm_b32 v166, v149, v145, s79
    v_perm_b32 v167, v157, v153, s79
    s_nop 1
    v_mfma_f32_16x16x32_bf16 v[24:27], v[224:227], v[160:163], v[24:27]
    v_mfma_f32_16x16x32_bf16 v[28:31], v[224:227], v[164:167], v[28:31]
    v_perm_b32 v160, v134, v130, s78
    v_perm_b32 v161, v142, v138, s78
    v_perm_b32 v162, v150, v146, s78
    v_perm_b32 v163, v158, v154, s78
    v_perm_b32 v164, v134, v130, s79
    v_perm_b32 v165, v142, v138, s79
    v_perm_b32 v166, v150, v146, s79
    v_perm_b32 v167, v158, v154, s79
    s_nop 1
    v_mfma_f32_16x16x32_bf16 v[32:35], v[224:227], v[160:163], v[32:35]
    v_mfma_f32_16x16x32_bf16 v[36:39], v[224:227], v[164:167], v[36:39]
    v_perm_b32 v160, v135, v131, s78
    v_perm_b32 v161, v143, v139, s78
    v_perm_b32 v162, v151, v147, s78
    v_perm_b32 v163, v159, v155, s78
    v_perm_b32 v164, v135, v131, s79
    v_perm_b32 v165, v143, v139, s79
    v_perm_b32 v166, v151, v147, s79
    v_perm_b32 v167, v159, v155, s79
    s_nop 1
    v_mfma_f32_16x16x32_bf16 v[40:43], v[224:227], v[160:163], v[40:43]
    v_mfma_f32_16x16x32_bf16 v[44:47], v[224:227], v[164:167], v[44:47]
    v_lshlrev_b32 v1, 4, v0
    v_lshrrev_b32 v200, 4, v0
    v_add_u32 v1, s15, v1
    v_add_u32 v2, s15, v10
    s_nop 7
    v_mov_b32 v96, v16
    v_mov_b32 v97, v20
    v_mov_b32 v98, v24
    v_mov_b32 v99, v28
    v_mov_b32 v100, v32
    v_mov_b32 v101, v36
    v_mov_b32 v102, v40
    v_mov_b32 v103, v44
    v_mov_b32 v104, v17
    v_mov_b32 v105, v21
    v_mov_b32 v106, v25
    v_mov_b32 v107, v29
    v_mov_b32 v108, v33
    v_mov_b32 v109, v37
    v_mov_b32 v110, v41
    v_mov_b32 v111, v45
    v_mov_b32 v112, v18
    v_mov_b32 v113, v22
    v_mov_b32 v114, v26
    v_mov_b32 v115, v30
    v_mov_b32 v116, v34
    v_mov_b32 v117, v38
    v_mov_b32 v118, v42
    v_mov_b32 v119, v46
    v_mov_b32 v120, v19
    v_mov_b32 v121, v23
    v_mov_b32 v122, v27
    v_mov_b32 v123, v31
    v_mov_b32 v124, v35
    v_mov_b32 v125, v39
    v_mov_b32 v126, v43
    v_mov_b32 v127, v47
    s_mov_b32 exec_lo, 0xff0000ff
    s_mov_b32 exec_hi, 0
    ds_write_b128 v2, v[96:99] offset:0
    ds_write_b128 v2, v[100:103] offset:16
    ds_write_b128 v2, v[104:107] offset:256
    ds_write_b128 v2, v[108:111] offset:272
    ds_write_b128 v2, v[112:115] offset:512
    ds_write_b128 v2, v[116:119] offset:528
    ds_write_b128 v2, v[120:123] offset:768
    ds_write_b128 v2, v[124:127] offset:784
    s_mov_b64 exec, -1
    s_waitcnt lgkmcnt(0)
    ds_read_b128 v[192:195], v1
    ds_read_b128 v[196:199], v1 offset:1024
    s_waitcnt lgkmcnt(0)
    v_add_f32 v192, v192, v196
    v_add_f32 v193, v193, v197
    v_add_f32 v194, v194, v198
    v_add_f32 v195, v195, v199
    v_add_u32 v192, 0x200, v192
    v_add_u32 v193, 0x200, v193
    v_add_u32 v194, 0x200, v194
    v_add_u32 v195, 0x200, v195
    v_bfi_b32 v192, s96, v188, v192
    v_bfi_b32 v193, s96, v189, v193
    v_bfi_b32 v194, s96, v190, v194
    v_bfi_b32 v195, s96, v191, v195
    s_sub_u32 s5, s2, 112
    s_lshr_b32 s4, s5, 3
    s_add_u32 s4, s4, 128
    s_lshl_b32 s4, s4, 9
    s_and_b32 s5, s5, 7
    s_lshl_b32 s5, s5, 4
    s_add_u32 s4, s4, s5
    s_lshl_b32 s4, s4, 4
    s_add_u32 s4, s4, 1097728
    v_and_b32 v1, 15, v0
    v_lshl_add_u32 v1, v200, 7, v1
    v_lshlrev_b32 v1, 4, v1
    s_nop 1
    buffer_store_dwordx4 v[192:195], v1, s[64:67], s4 offen sc1
L_secAG:
    s_lshl_b32 s4, s3, 5
    s_lshr_b32 s5, s2, 3
    s_add_u32 s4, s4, s5
    s_lshl_b32 s6, s4, 2
    s_bfe_u32 s5, s2, 0x20001
    s_add_u32 s6, s6, s5
    s_lshl_b32 s6, s6, 10
    s_add_u32 s6, s6, 442368
    s_lshl_b32 s4, s4, 10
    s_add_u32 s4, s4, 966656
    v_lshlrev_b32 v4, 7, v61
    s_mov_b32 s90, 100000
L_poll_a:
    buffer_load_dwordx4 v[16:19], v3, s[64:67], s6 offen sc1
    buffer_load_dwordx4 v[20:23], v4, s[64:67], s4 offen sc1
    s_waitcnt vmcnt(0)
    v_xor_b32 v6, v16, v188
    v_xor_b32 v7, v17, v189
    v_or_b32 v6, v6, v7
    v_xor_b32 v7, v18, v190
    v_or_b32 v6, v6, v7
    v_xor_b32 v7, v19, v191
    v_or_b32 v6, v6, v7
    v_xor_b32 v7, v20, v188
    v_or_b32 v6, v6, v7
    v_xor_b32 v7, v21, v189
    v_or_b32 v6, v6, v7
    v_xor_b32 v7, v22, v190
    v_or_b32 v6, v6, v7
    v_xor_b32 v7, v23, v191
    v_or_b32 v6, v6, v7
    v_and_b32 v6, 0x3ff, v6
    v_cmp_ne_u32 vcc, 0, v6
    s_nop 1
    s_cmp_eq_u64 vcc, 0
    s_cbranch_scc1 L_pdone_a
    s_sub_u32 s90, s90, 1
    s_cmp_eq_u32 s90, 0
    s_cbranch_scc1 L_pdone_a
    s_branch L_poll_a
L_pdone_a:
    v_and_b32 v16, 0xfffffc00, v16
    v_and_b32 v17, 0xfffffc00, v17
    v_and_b32 v18, 0xfffffc00, v18
    v_and_b32 v19, 0xfffffc00, v19
    v_and_b32 v20, 0xfffffc00, v20
    v_and_b32 v21, 0xfffffc00, v21
    v_and_b32 v22, 0xfffffc00, v22
    v_and_b32 v23, 0xfffffc00, v23
    v_mov_b32 v24, v20
    s_nop 1
    v_max_f32_dpp v24, v24, v24 row_ror:8 row_mask:0xf bank_mask:0xf
    v_mov_b32 v25, v24
    s_nop 1
    v_permlane16_swap_b32 v24, v25
    s_nop 1
    v_max_f32 v24, v24, v25
    v_mov_b32 v25, v24
    s_nop 1
    v_permlane32_swap_b32 v24, v25
    s_nop 1
    v_max_f32 v24, v24, v25
    v_sub_f32 v25, v20, v24
    v_mul_f32 v25, 0x3fb8aa3b, v25
    v_exp_f32 v25, v25
    s_nop 0
    v_mul_f32 v26, v25, v21
    v_mul_f32 v84, v25, v16
    v_mul_f32 v85, v25, v17
    v_mul_f32 v86, v25, v18
    v_mul_f32 v87, v25, v19
    s_nop 1
    v_add_f32_dpp v26, v26, v26 row_ror:8 row_mask:0xf bank_mask:0xf
    v_add_f32_dpp v84, v84, v84 row_ror:8 row_mask:0xf bank_mask:0xf
    v_add_f32_dpp v85, v85, v85 row_ror:8 row_mask:0xf bank_mask:0xf
    v_add_f32_dpp v86, v86, v86 row_ror:8 row_mask:0xf bank_mask:0xf
    v_add_f32_dpp v87, v87, v87 row_ror:8 row_mask:0xf bank_mask:0xf
    v_mov_b32 v27, v26
    v_mov_b32 v28, v84
    v_mov_b32 v29, v85
    v_mov_b32 v30, v86
    v_mov_b32 v31, v87
    s_nop 1
    v_permlane16_swap_b32 v26, v27
    v_permlane16_swap_b32 v84, v28
    v_permlane16_swap_b32 v85, v29
    v_permlane16_swap_b32 v86, v30
    v_permlane16_swap_b32 v87, v31
    s_nop 1
    v_add_f32 v26, v26, v27
    v_add_f32 v84, v84, v28
    v_add_f32 v85, v85, v29
    v_add_f32 v86, v86, v30
    v_add_f32 v87, v87, v31
    v_mov_b32 v27, v26
    v_mov_b32 v28, v84
    v_mov_b32 v29, v85
    v_mov_b32 v30, v86
    v_mov_b32 v31, v87
    s_nop 1
    v_permlane32_swap_b32 v26, v27
    v_permlane32_swap_b32 v84, v28
    v_permlane32_swap_b32 v85, v29
    v_permlane32_swap_b32 v86, v30
    v_permlane32_swap_b32 v87, v31
    s_nop 1
    v_add_f32 v26, v26, v27
    v_add_f32 v84, v84, v28
    v_add_f32 v85, v85, v29
    v_add_f32 v86, v86, v30
    v_add_f32 v87, v87, v31
    v_rcp_f32 v27, v26
    s_nop 0
    v_fma_f32 v28, -v26, v27, 2.0
    v_mul_f32 v27, v27, v28
    v_mul_f32 v84, v27, v84
    v_mul_f32 v85, v27, v85
    v_mul_f32 v86, v27, v86
    v_mul_f32 v87, v27, v87
    v_cvt_pk_bf16_f32 v84, v84, v85
    v_cvt_pk_bf16_f32 v85, v86, v87
    s_lshl_b32 s4, s3, 6
    v_lshlrev_b32 v4, 3, v0
    v_add_u32 v4, s4, v4
    s_mov_b64 exec, 0xff
    ds_write_b64 v4, v[84:85] offset:17536
    s_mov_b64 exec, -1
    s_waitcnt lgkmcnt(0)
    v_mov_b32 v6, 19852
    v_mov_b32 v7, 1
    s_mov_b64 exec, 1
    ds_add_u32 v6, v7
    s_mov_b64 exec, -1
    s_nop 1
    s_cmp_lt_u32 s3, 2
    s_cbranch_scc1 L_secC_done
L_secC:
    s_lshr_b32 s4, s2, 1
    s_lshl_b32 s4, s4, 9
    s_and_b32 s5, s2, 1
    s_lshl_b32 s5, s5, 6
    s_add_u32 s4, s4, s5
    s_sub_u32 s5, s3, 2
    s_lshl_b32 s5, s5, 5
    s_add_u32 s4, s4, s5
    s_lshl_b32 s4, s4, 4
    s_add_u32 s4, s4, 1097728
    s_add_u32 s5, s4, 4096
    v_lshlrev_b32 v2, 5, v0
    v_and_b32 v1, 3, v0
    v_lshlrev_b32 v1, 6, v1
    v_lshrrev_b32 v9, 4, v0
    v_lshl_add_u32 v1, v9, 4, v1
    v_mov_b32 v6, 19852
    s_mov_b32 s91, 4000000
L_lw5:
    ds_read_b32 v7, v6
    s_waitcnt lgkmcnt(0)
    v_readfirstlane_b32 s92, v7
    s_nop 1
    s_nop 1
    s_cmp_ge_u32 s92, 4
    s_cbranch_scc1 L_lwd5
    s_sub_u32 s91, s91, 1
    s_cmp_eq_u32 s91, 0
    s_cbranch_scc1 L_lwd5
    s_sleep 1
    s_branch L_lw5
L_lwd5:
    ds_read_b128 v[12:15], v1 offset:17536
    s_waitcnt vmcnt(0)
    s_waitcnt lgkmcnt(0)
    v_perm_b32 v160, v100, v96, s78
    v_perm_b32 v161, v108, v104, s78
    v_perm_b32 v162, v116, v112, s78
    v_perm_b32 v163, v124, v120, s78
    v_perm_b32 v164, v100, v96, s79
    v_perm_b32 v165, v108, v104, s79
    v_perm_b32 v166, v116, v112, s79
    v_perm_b32 v167, v124, v120, s79
    s_nop 1
    v_mfma_f32_16x16x32_bf16 v[16:19], v[12:15], v[160:163], 0
    v_mfma_f32_16x16x32_bf16 v[20:23], v[12:15], v[164:167], 0
    v_perm_b32 v160, v101, v97, s78
    v_perm_b32 v161, v109, v105, s78
    v_perm_b32 v162, v117, v113, s78
    v_perm_b32 v163, v125, v121, s78
    v_perm_b32 v164, v101, v97, s79
    v_perm_b32 v165, v109, v105, s79
    v_perm_b32 v166, v117, v113, s79
    v_perm_b32 v167, v125, v121, s79
    s_nop 1
    v_mfma_f32_16x16x32_bf16 v[24:27], v[12:15], v[160:163], 0
    v_mfma_f32_16x16x32_bf16 v[28:31], v[12:15], v[164:167], 0
    v_perm_b32 v160, v102, v98, s78
    v_perm_b32 v161, v110, v106, s78
    v_perm_b32 v162, v118, v114, s78
    v_perm_b32 v163, v126, v122, s78
    v_perm_b32 v164, v102, v98, s79
    v_perm_b32 v165, v110, v106, s79
    v_perm_b32 v166, v118, v114, s79
    v_perm_b32 v167, v126, v122, s79
    s_nop 1
    v_mfma_f32_16x16x32_bf16 v[32:35], v[12:15], v[160:163], 0
    v_mfma_f32_16x16x32_bf16 v[36:39], v[12:15], v[164:167], 0
    v_perm_b32 v160, v103, v99, s78
    v_perm_b32 v161, v111, v107, s78
    v_perm_b32 v162, v119, v115, s78
    v_perm_b32 v163, v127, v123, s78
    v_perm_b32 v164, v103, v99, s79
    v_perm_b32 v165, v111, v107, s79
    v_perm_b32 v166, v119, v115, s79
    v_perm_b32 v167, v127, v123, s79
    s_nop 1
    v_mfma_f32_16x16x32_bf16 v[40:43], v[12:15], v[160:163], 0
    v_mfma_f32_16x16x32_bf16 v[44:47], v[12:15], v[164:167], 0
    s_nop 7
    s_nop 1
    v_and_b32 v6, 16, v0
    v_cmp_ne_u32 s[90:91], 0, v6
    v_cmp_lt_u32 s[92:93], 31, v0
    s_nop 1
    v_cndmask_b32 v208, v16, v32, s[90:91]
    v_cndmask_b32 v209, v18, v34, s[90:91]
    v_cndmask_b32 v200, v208, v209, s[92:93]
    v_cndmask_b32 v208, v20, v36, s[90:91]
    v_cndmask_b32 v209, v22, v38, s[90:91]
    v_cndmask_b32 v201, v208, v209, s[92:93]
    v_cndmask_b32 v208, v24, v40, s[90:91]
    v_cndmask_b32 v209, v26, v42, s[90:91]
    v_cndmask_b32 v202, v208, v209, s[92:93]
    v_cndmask_b32 v208, v28, v44, s[90:91]
    v_cndmask_b32 v209, v30, v46, s[90:91]
    v_cndmask_b32 v203, v208, v209, s[92:93]
    v_add_u32 v192, 0x200, v200
    v_add_u32 v193, 0x200, v201
    v_add_u32 v194, 0x200, v202
    v_add_u32 v195, 0x200, v203
    v_bfi_b32 v192, s96, v188, v192
    v_bfi_b32 v193, s96, v189, v193
    v_bfi_b32 v194, s96, v190, v194
    v_bfi_b32 v195, s96, v191, v195
    v_cndmask_b32 v208, v17, v33, s[90:91]
    v_cndmask_b32 v209, v19, v35, s[90:91]
    v_cndmask_b32 v204, v208, v209, s[92:93]
    v_cndmask_b32 v208, v21, v37, s[90:91]
    v_cndmask_b32 v209, v23, v39, s[90:91]
    v_cndmask_b32 v205, v208, v209, s[92:93]
    v_cndmask_b32 v208, v25, v41, s[90:91]
    v_cndmask_b32 v209, v27, v43, s[90:91]
    v_cndmask_b32 v206, v208, v209, s[92:93]
    v_cndmask_b32 v208, v29, v45, s[90:91]
    v_cndmask_b32 v209, v31, v47, s[90:91]
    v_cndmask_b32 v207, v208, v209, s[92:93]
    v_add_u32 v196, 0x200, v204
    v_add_u32 v197, 0x200, v205
    v_add_u32 v198, 0x200, v206
    v_add_u32 v199, 0x200, v207
    v_bfi_b32 v196, s96, v188, v196
    v_bfi_b32 v197, s96, v189, v197
    v_bfi_b32 v198, s96, v190, v198
    v_bfi_b32 v199, s96, v191, v199
    v_and_b32 v2, 15, v0
    v_lshlrev_b32 v2, 5, v2
    v_add_u32 v2, v6, v2
    v_lshrrev_b32 v6, 5, v0
    v_lshl_add_u32 v2, v6, 12, v2
    buffer_store_dwordx4 v[192:195], v2, s[64:67], s4 offen offset:0 sc1
    buffer_store_dwordx4 v[196:199], v2, s[64:67], s4 offen offset:2048 sc1
L_secC_done:
    s_cmp_lt_u32 s2, 64
    s_cbranch_scc1 L_secF
    s_nop 1
    s_branch L_exit_c
L_secF:
    v_lshlrev_b32 v76, 16, v68
    v_and_b32 v77, 0xffff0000, v68
    v_lshlrev_b32 v78, 16, v64
    v_and_b32 v79, 0xffff0000, v64
    v_mul_f32 v76, v76, v78
    v_mul_f32 v77, v77, v79
    v_cvt_pk_bf16_f32 v78, v76, v77
    v_lshlrev_b32 v76, 16, v78
    v_and_b32 v77, 0xffff0000, v78
    v_add_f32 v74, v76, v77
    v_lshlrev_b32 v76, 16, v69
    v_and_b32 v77, 0xffff0000, v69
    v_lshlrev_b32 v78, 16, v65
    v_and_b32 v79, 0xffff0000, v65
    v_mul_f32 v76, v76, v78
    v_mul_f32 v77, v77, v79
    v_cvt_pk_bf16_f32 v78, v76, v77
    v_lshlrev_b32 v76, 16, v78
    v_and_b32 v77, 0xffff0000, v78
    v_add_f32 v74, v74, v76
    v_add_f32 v74, v74, v77
    v_lshlrev_b32 v76, 16, v70
    v_and_b32 v77, 0xffff0000, v70
    v_lshlrev_b32 v78, 16, v66
    v_and_b32 v79, 0xffff0000, v66
    v_mul_f32 v76, v76, v78
    v_mul_f32 v77, v77, v79
    v_cvt_pk_bf16_f32 v78, v76, v77
    v_lshlrev_b32 v76, 16, v78
    v_and_b32 v77, 0xffff0000, v78
    v_add_f32 v74, v74, v76
    v_add_f32 v74, v74, v77
    v_lshlrev_b32 v76, 16, v71
    v_and_b32 v77, 0xffff0000, v71
    v_lshlrev_b32 v78, 16, v67
    v_and_b32 v79, 0xffff0000, v67
    v_mul_f32 v76, v76, v78
    v_mul_f32 v77, v77, v79
    v_cvt_pk_bf16_f32 v78, v76, v77
    v_lshlrev_b32 v76, 16, v78
    v_and_b32 v77, 0xffff0000, v78
    v_add_f32 v74, v74, v76
    v_add_f32 v74, v74, v77
    s_nop 1
    v_add_f32_dpp v74, v74, v74 quad_perm:[1,0,3,2] row_mask:0xf bank_mask:0xf
    s_nop 1
    v_add_f32_dpp v74, v74, v74 quad_perm:[2,3,0,1] row_mask:0xf bank_mask:0xf
    s_nop 1
    v_add_f32_dpp v74, v74, v74 row_half_mirror row_mask:0xf bank_mask:0xf
    s_nop 1
    v_add_f32_dpp v74, v74, v74 row_mirror row_mask:0xf bank_mask:0xf
    v_mov_b32 v76, v74
    s_nop 1
    v_permlane16_swap_b32 v74, v76
    s_nop 1
    v_add_f32 v74, v74, v76
    v_mov_b32 v76, v74
    s_nop 1
    v_permlane32_swap_b32 v74, v76
    s_nop 1
    v_add_f32 v74, v74, v76
    v_cvt_pk_bf16_f32 v75, v74, v74
    v_lshlrev_b32 v75, 16, v75
    v_mul_f32 v75, 0xbfb8aa3b, v75
    v_exp_f32 v75, v75
    s_nop 0
    v_add_f32 v75, 1.0, v75
    v_rcp_f32 v76, v75
    s_nop 0
    v_fma_f32 v77, -v75, v76, 2.0
    v_mul_f32 v76, v76, v77
    v_cvt_pk_bf16_f32 v76, v76, v76
    v_lshlrev_b32 v75, 16, v76
    v_sub_f32 v76, 1.0, v75
    v_cvt_pk_bf16_f32 v76, v76, v76
    v_lshlrev_b32 v76, 16, v76
    v_lshlrev_b32 v73, 16, v72
    s_mov_b32 s90, 100000
L_poll_o:
    buffer_load_dwordx4 v[32:35], v60, s[64:67], s86 offen sc1
    buffer_load_dwordx4 v[36:39], v60, s[64:67], s87 offen sc1
    buffer_load_dwordx4 v[40:43], v60, s[64:67], s88 offen sc1
    buffer_load_dwordx4 v[44:47], v60, s[64:67], s89 offen sc1
    buffer_load_dwordx4 v[48:51], v62, s[64:67], s85 offen sc1
    s_waitcnt vmcnt(0)
    v_xor_b32 v1, v32, v188
    v_xor_b32 v2, v33, v189
    v_or_b32 v1, v1, v2
    v_xor_b32 v2, v34, v190
    v_or_b32 v1, v1, v2
    v_xor_b32 v2, v35, v191
    v_or_b32 v1, v1, v2
    v_xor_b32 v2, v36, v188
    v_or_b32 v1, v1, v2
    v_xor_b32 v2, v37, v189
    v_or_b32 v1, v1, v2
    v_xor_b32 v2, v38, v190
    v_or_b32 v1, v1, v2
    v_xor_b32 v2, v39, v191
    v_or_b32 v1, v1, v2
    v_xor_b32 v2, v40, v188
    v_or_b32 v1, v1, v2
    v_xor_b32 v2, v41, v189
    v_or_b32 v1, v1, v2
    v_xor_b32 v2, v42, v190
    v_or_b32 v1, v1, v2
    v_xor_b32 v2, v43, v191
    v_or_b32 v1, v1, v2
    v_xor_b32 v2, v44, v188
    v_or_b32 v1, v1, v2
    v_xor_b32 v2, v45, v189
    v_or_b32 v1, v1, v2
    v_xor_b32 v2, v46, v190
    v_or_b32 v1, v1, v2
    v_xor_b32 v2, v47, v191
    v_or_b32 v1, v1, v2
    v_xor_b32 v2, v48, v188
    v_or_b32 v1, v1, v2
    v_xor_b32 v2, v49, v189
    v_or_b32 v1, v1, v2
    v_xor_b32 v2, v50, v190
    v_or_b32 v1, v1, v2
    v_xor_b32 v2, v51, v191
    v_or_b32 v1, v1, v2
    v_and_b32 v1, 0x3ff, v1
    v_cmp_ne_u32 vcc, 0, v1
    s_nop 1
    s_cmp_eq_u64 vcc, 0
    s_cbranch_scc1 L_pdone_o
    s_sub_u32 s90, s90, 1
    s_cmp_eq_u32 s90, 0
    s_cbranch_scc1 L_pdone_o
    s_branch L_poll_o
L_pdone_o:
    v_and_b32 v32, 0xfffffc00, v32
    v_and_b32 v33, 0xfffffc00, v33
    v_and_b32 v34, 0xfffffc00, v34
    v_and_b32 v35, 0xfffffc00, v35
    v_and_b32 v36, 0xfffffc00, v36
    v_and_b32 v37, 0xfffffc00, v37
    v_and_b32 v38, 0xfffffc00, v38
    v_and_b32 v39, 0xfffffc00, v39
    v_and_b32 v40, 0xfffffc00, v40
    v_and_b32 v41, 0xfffffc00, v41
    v_and_b32 v42, 0xfffffc00, v42
    v_and_b32 v43, 0xfffffc00, v43
    v_and_b32 v44, 0xfffffc00, v44
    v_and_b32 v45, 0xfffffc00, v45
    v_and_b32 v46, 0xfffffc00, v46
    v_and_b32 v47, 0xfffffc00, v47
    v_and_b32 v48, 0xfffffc00, v48
    v_and_b32 v49, 0xfffffc00, v49
    v_and_b32 v50, 0xfffffc00, v50
    v_and_b32 v51, 0xfffffc00, v51
    s_lshl_b32 s5, s3, 5
    s_sub_u32 s5, 112, s5
    s_min_u32 s5, s5, 32
    v_cmp_gt_u32 vcc, s5, v0
    s_nop 1
    v_cndmask_b32 v92, 0, v48, vcc
    v_add_f32 v88, v32, v36
    v_add_f32 v52, v40, v44
    v_cndmask_b32 v93, 0, v49, vcc
    v_add_f32 v89, v33, v37
    v_add_f32 v53, v41, v45
    v_cndmask_b32 v94, 0, v50, vcc
    v_add_f32 v90, v34, v38
    v_add_f32 v54, v42, v46
    v_cndmask_b32 v95, 0, v51, vcc
    v_add_f32 v91, v35, v39
    v_add_f32 v55, v43, v47
    v_add_f32 v88, v88, v52
    v_add_f32 v89, v89, v53
    v_add_f32 v90, v90, v54
    v_add_f32 v91, v91, v55
    s_nop 1
    v_add_f32_dpp v88, v88, v88 row_ror:8 row_mask:0xf bank_mask:0xf
    v_add_f32_dpp v89, v89, v89 row_ror:8 row_mask:0xf bank_mask:0xf
    v_add_f32_dpp v90, v90, v90 row_ror:8 row_mask:0xf bank_mask:0xf
    v_add_f32_dpp v91, v91, v91 row_ror:8 row_mask:0xf bank_mask:0xf
    v_add_f32_dpp v92, v92, v92 row_ror:8 row_mask:0xf bank_mask:0xf
    v_add_f32_dpp v93, v93, v93 row_ror:8 row_mask:0xf bank_mask:0xf
    v_add_f32_dpp v94, v94, v94 row_ror:8 row_mask:0xf bank_mask:0xf
    v_add_f32_dpp v95, v95, v95 row_ror:8 row_mask:0xf bank_mask:0xf
    v_mov_b32 v52, v88
    v_mov_b32 v53, v89
    v_mov_b32 v54, v90
    v_mov_b32 v55, v91
    v_mov_b32 v56, v92
    v_mov_b32 v57, v93
    v_mov_b32 v58, v94
    v_mov_b32 v59, v95
    s_nop 1
    v_permlane16_swap_b32 v88, v52
    v_permlane16_swap_b32 v89, v53
    v_permlane16_swap_b32 v90, v54
    v_permlane16_swap_b32 v91, v55
    v_permlane16_swap_b32 v92, v56
    v_permlane16_swap_b32 v93, v57
    v_permlane16_swap_b32 v94, v58
    v_permlane16_swap_b32 v95, v59
    s_nop 1
    v_add_f32 v88, v88, v52
    v_add_f32 v89, v89, v53
    v_add_f32 v90, v90, v54
    v_add_f32 v91, v91, v55
    v_add_f32 v92, v92, v56
    v_add_f32 v93, v93, v57
    v_add_f32 v94, v94, v58
    v_add_f32 v95, v95, v59
    v_mov_b32 v52, v88
    v_mov_b32 v53, v89
    v_mov_b32 v54, v90
    v_mov_b32 v55, v91
    v_mov_b32 v56, v92
    v_mov_b32 v57, v93
    v_mov_b32 v58, v94
    v_mov_b32 v59, v95
    s_nop 1
    v_permlane32_swap_b32 v88, v52
    v_permlane32_swap_b32 v89, v53
    v_permlane32_swap_b32 v90, v54
    v_permlane32_swap_b32 v91, v55
    v_permlane32_swap_b32 v92, v56
    v_permlane32_swap_b32 v93, v57
    v_permlane32_swap_b32 v94, v58
    v_permlane32_swap_b32 v95, v59
    s_nop 1
    v_add_f32 v88, v88, v52
    v_add_f32 v89, v89, v53
    v_add_f32 v90, v90, v54
    v_add_f32 v91, v91, v55
    v_add_f32 v92, v92, v56
    v_add_f32 v93, v93, v57
    v_add_f32 v94, v94, v58
    v_add_f32 v95, v95, v59
    s_lshl_b32 s4, s3, 7
    v_add_u32 v4, s4, v3
    s_mov_b64 exec, 0xff
    ds_write_b128 v4, v[88:91] offset:18816
    ds_write_b128 v4, v[92:95] offset:19328
    s_mov_b64 exec, -1
    s_waitcnt lgkmcnt(0)
    v_mov_b32 v6, 19856
    v_mov_b32 v7, 1
    s_mov_b64 exec, 1
    ds_add_u32 v6, v7
    s_mov_b64 exec, -1
    s_cmp_lg_u32 s3, 0
    s_cbranch_scc1 L_exit_c
    v_mov_b32 v6, 19856
    s_mov_b32 s91, 4000000
L_lw6:
    ds_read_b32 v7, v6
    s_waitcnt lgkmcnt(0)
    v_readfirstlane_b32 s92, v7
    s_nop 1
    s_nop 1
    s_cmp_ge_u32 s92, 4
    s_cbranch_scc1 L_lwd6
    s_sub_u32 s91, s91, 1
    s_cmp_eq_u32 s91, 0
    s_cbranch_scc1 L_lwd6
    s_sleep 1
    s_branch L_lw6
L_lwd6:
    v_and_b32 v6, 31, v0
    v_lshlrev_b32 v4, 2, v6
    ds_read_b32 v52, v4 offset:18816
    ds_read_b32 v53, v4 offset:18944
    ds_read_b32 v54, v4 offset:19072
    ds_read_b32 v55, v4 offset:19200
    ds_read_b32 v56, v4 offset:19328
    ds_read_b32 v57, v4 offset:19456
    ds_read_b32 v58, v4 offset:19584
    ds_read_b32 v59, v4 offset:19712
    s_waitcnt lgkmcnt(0)
    v_add_f32 v52, v52, v53
    v_add_f32 v54, v54, v55
    v_add_f32 v56, v56, v57
    v_add_f32 v58, v58, v59
    v_add_f32 v52, v52, v54
    v_add_f32 v56, v56, v58
    v_cvt_pk_bf16_f32 v54, v52, v56
    v_lshlrev_b32 v52, 16, v54
    v_and_b32 v56, 0xffff0000, v54
    v_add_f32 v56, v56, v73
    v_cvt_pk_bf16_f32 v54, v56, v56
    v_lshlrev_b32 v56, 16, v54
    v_mul_f32 v52, v75, v52
    v_mul_f32 v56, v76, v56
    v_cvt_pk_bf16_f32 v54, v52, v56
    v_lshlrev_b32 v52, 16, v54
    v_and_b32 v56, 0xffff0000, v54
    v_add_f32 v52, v52, v56
    v_cvt_pk_bf16_f32 v52, v52, v52
    v_lshlrev_b32 v6, 1, v6
    s_lshl_b32 s4, s2, 6
    s_nop 1
    s_mov_b32 s68, s38
    s_and_b32 s69, s39, 0xffff
    s_mov_b32 s70, 4096
    s_mov_b32 s71, 0x00020000
    s_mov_b32 exec_lo, -1
    s_mov_b32 exec_hi, 0
    buffer_store_short v52, v6, s[68:71], s4 offen
    s_cmp_lg_u32 s2, 0
    s_cbranch_scc1 L_exit_c
    s_mov_b64 exec, 1
    v_mov_b32 v1, 0
    v_mov_b32 v4, s76
    v_mov_b32 v5, s77
    buffer_store_dwordx2 v[4:5], v1, s[64:67], 0 offen offset:0 sc1
L_exit_c:
L_exit:
    s_endpgm
L_dry_done_data:
L_dry_done_comm:
    s_endpgm
.section .rodata,"a"
.p2align 6
.amdhsa_kernel gated_mix__sliding_block_cached__mixer_channel_mlp__decode_kernel
  .amdhsa_next_free_vgpr 240
  .amdhsa_next_free_sgpr 102
  .amdhsa_accum_offset 240
  .amdhsa_group_segment_fixed_size 0
  .amdhsa_kernarg_size 112
  .amdhsa_user_sgpr_count 2
  .amdhsa_user_sgpr_kernarg_segment_ptr 1
  .amdhsa_system_sgpr_workgroup_id_x 1
.end_amdhsa_kernel
```
